```python
import torch

def _softmax(x, axis=-1):
    return torch.softmax(x, dim=axis)
def _gelu(x):
    return torch.nn.functional.gelu(x, approximate="tanh")
def _silu(x):
    return torch.nn.functional.silu(x)
def _sigmoid(x):
    return torch.sigmoid(x)
def _layernorm(x, axis=-1, eps=1e-5):
    m = x.mean(dim=axis, keepdim=True)
    v = x.var(dim=axis, keepdim=True, unbiased=False)
    return (x - m) / torch.sqrt(v + eps)
def _scatter_add(tgt, idx, src, axis=0):
    return tgt.clone().index_add_(axis, idx, src)
def _segment_sum(src, seg, n):
    out = torch.zeros((n,) + src.shape[1:], dtype=src.dtype)
    return out.index_add_(0, seg, src)
def _pad(x, pw):
    flat = tuple(v for pair in reversed(pw) for v in pair)
    return torch.nn.functional.pad(x, flat)

kernel_name = 'concat_heads__gqa_block_cached__mha_block_cached__near_ridge'

def setup_inputs():

    _w = (lambda a: (lambda t: t.to(torch.bfloat16) if t.is_floating_point() else t)(torch.as_tensor(a)))
    def _A_setup():
        B, Sq, D = 8, 96, 448
        Hq, Hkv, Sk, Dh = 16, 8, 512, 256
        assert Hq % Hkv == 0, (Hq, Hkv)
        return {
            "x": _w((lambda *s: torch.randn(*s, dtype=torch.bfloat16) * 0.8)(B, Sq, D)),
            "k_cache": _w((lambda *s: torch.randn(*s, dtype=torch.bfloat16) * 0.8)(B, Hkv, Sk, Dh)),
            "v_cache": _w((lambda *s: torch.randn(*s, dtype=torch.bfloat16) * 0.05)(B, Hkv, Sk, Dh)),
            "wq": _w((lambda *s: torch.randn(*s, dtype=torch.bfloat16) * 0.8)(D, Hq * Dh) * (D ** -0.5)),
            "wo": _w((lambda *s: torch.randn(*s, dtype=torch.bfloat16) * 0.05)(Hq * Dh, D) * ((Hq * Dh) ** -0.5)),
        }
    _A_in = _A_setup()

    def _B_setup():
        B, Sq, D = 8, 96, 448
        H, Sk, Dh = 16, 512, 256
        return {
            "x": _w((lambda *s: torch.randn(*s, dtype=torch.bfloat16) * 0.8)(B, Sq, D)),
            "k_cache": _w((lambda *s: torch.randn(*s, dtype=torch.bfloat16) * 0.8)(B, H, Sk, Dh)),
            "v_cache": _w((lambda *s: torch.randn(*s, dtype=torch.bfloat16) * 0.05)(B, H, Sk, Dh)),
            "wq": _w((lambda *s: torch.randn(*s, dtype=torch.bfloat16) * 0.8)(D, H * Dh) * (D ** -0.5)),
            "wo": _w((lambda *s: torch.randn(*s, dtype=torch.bfloat16) * 0.05)(H * Dh, D) * ((H * Dh) ** -0.5)),
        }
    _B_in = _B_setup()

    return {
        "A_x": _A_in["x"],
        "A_k_cache": _A_in["k_cache"],
        "A_v_cache": _A_in["v_cache"],
        "A_wq": _A_in["wq"],
        "A_wo": _A_in["wo"],
        "B_x": _B_in["x"],
        "B_k_cache": _B_in["k_cache"],
        "B_v_cache": _B_in["v_cache"],
        "B_wq": _B_in["wq"],
        "B_wo": _B_in["wo"],
    }

def reference(A_x, A_k_cache, A_v_cache, A_wq, A_wo, B_x, B_k_cache, B_v_cache, B_wq, B_wo):
    def _A_ref(x, k_cache, v_cache, wq, wo):
        B, Sq, D = x.shape
        Hq, Dh = 16, 256
        Hkv = k_cache.shape[1]
        rep = Hq // Hkv
        q = (lambda x, *d: x.permute(*d))((x @ wq).reshape(B, Sq, Hq, Dh), 0, 2, 1, 3)
        k = (lambda x, n, axis: torch.repeat_interleave(x, n, dim=axis))(k_cache, rep, axis=1)
        v = (lambda x, n, axis: torch.repeat_interleave(x, n, dim=axis))(v_cache, rep, axis=1)
        scores = torch.einsum("bhqd,bhkd->bhqk", q, k) * (Dh ** -0.5)
        p = _softmax(scores, axis=-1)
        o = torch.einsum("bhqk,bhkd->bhqd", p, v)
        return (lambda x, *d: x.permute(*d))(o, 0, 2, 1, 3).reshape(B, Sq, Hq * Dh) @ wo

    def _B_ref(x, k_cache, v_cache, wq, wo):
        B, Sq, D = x.shape
        H, Dh = 16, 256
        q = (lambda x, *d: x.permute(*d))((x @ wq).reshape(B, Sq, H, Dh), 0, 2, 1, 3)
        scores = torch.einsum("bhqd,bhkd->bhqk", q, k_cache) * (Dh ** -0.5)
        p = _softmax(scores, axis=-1)
        o = torch.einsum("bhqk,bhkd->bhqd", p, v_cache)
        return (lambda x, *d: x.permute(*d))(o, 0, 2, 1, 3).reshape(B, Sq, H * Dh) @ wo

    a = _A_ref(A_x, A_k_cache, A_v_cache, A_wq, A_wo)
    b = _B_ref(B_x, B_k_cache, B_v_cache, B_wq, B_wo)
    return torch.concatenate([a, b], axis=-1)
```

```asm
; @launch grid=(256,1,1) block=(256,1,1) lds=163840
.amdgcn_target "amdgcn-amd-amdhsa--gfx950"
.text
.globl concat_heads__gqa_block_cached__mha_block_cached__near_ridge_kernel
.p2align 8
.type concat_heads__gqa_block_cached__mha_block_cached__near_ridge_kernel,@function
concat_heads__gqa_block_cached__mha_block_cached__near_ridge_kernel:
s_cmp_ge_u32 s2, 256
s_cbranch_scc1 L_k1_end
s_load_dwordx8 s[36:43], s[0:1], 0
s_load_dwordx2 s[44:45], s[0:1], 32
s_load_dwordx8 s[48:55], s[0:1], 40
s_load_dwordx2 s[56:57], s[0:1], 72
s_load_dwordx2 s[58:59], s[0:1], 96
s_load_dwordx4 s[96:99], s[0:1], 80
v_lshrrev_b32 v60, 6, v0
v_and_b32 v0, 63, v0
v_readfirstlane_b32 s3, v60
s_nop 3
s_cmp_lg_u32 s3, 0
s_cbranch_scc1 L_nopf0
s_getpc_b64 s[90:91]
L_pc0:
s_sub_u32 s90, s90, L_pc0-concat_heads__gqa_block_cached__mha_block_cached__near_ridge_kernel
s_subb_u32 s91, s91, 0
s_lshr_b32 s4, s2, 3
s_lshl_b32 s4, s4, 11
v_lshlrev_b32 v44, 7, v0
v_add_u32 v44, s4, v44
v_mov_b32 v47, s91
v_add_co_u32 v46, vcc, s90, v44
s_nop 1
v_addc_co_u32 v47, vcc, 0, v47, vcc
v_cmp_gt_u32 vcc, L_k1_end-concat_heads__gqa_block_cached__mha_block_cached__near_ridge_kernel, v44
s_nop 3
s_and_b64 exec, vcc, 0xffff
s_cbranch_execz L_nopfx0
global_load_dword v40, v[46:47], off
L_nopfx0:
s_mov_b64 exec, -1
s_nop 4
L_nopf0:
s_and_b32 s4, s2, 7
s_lshr_b32 s6, s2, 3
s_lshr_b32 s82, s6, 4
s_lshr_b32 s79, s6, 1
s_and_b32 s79, s79, 7
s_and_b32 s80, s6, 1
s_lshl_b32 s81, s4, 1
s_add_u32 s81, s81, s80
s_lshl_b32 s6, s79, 3
s_add_u32 s6, s6, s4
s_lshl_b32 s7, s79, 4
s_add_u32 s7, s7, s81
s_cmp_eq_u32 s82, 0
s_cselect_b32 s6, s6, s7
s_lshl_b32 s61, s6, 18
s_lshl_b32 s33, s3, 13
s_mul_i32 s34, s3, 12288
s_add_u32 s34, s34, 65536
s_lshl_b32 s35, s3, 10
s_mov_b32 s32, 0x3db8aa3b
s_lshl_b32 s83, s82, 3
s_add_u32 s83, s83, s79
s_mul_i32 s62, s80, 0
s_add_u32 s62, s62, s79
s_cmp_ge_u32 s62, 7
s_cselect_b32 s6, 7, 0
s_sub_u32 s62, s62, s6
v_lshrrev_b32 v49, 3, v0
v_and_b32 v50, 7, v0
v_lshrrev_b32 v51, 4, v0
v_and_b32 v52, 15, v0
v_and_b32 v44, 1, v51
v_lshlrev_b32 v44, 2, v44
v_xor_b32 v44, v50, v44
v_lshlrev_b32 v44, 4, v44
s_lshl_b32 s6, s3, 7
v_add_u32 v44, s6, v44
v_lshlrev_b32 v45, 13, v49
v_add_u32 v4, v44, v45
v_lshlrev_b32 v45, 9, v49
v_add_u32 v3, v44, v45
s_lshl_b32 s6, s3, 3
v_add_u32 v46, s6, v49
v_mul_u32_u24 v46, 896, v46
s_and_b32 s7, s3, 1
s_lshl_b32 s7, s7, 2
v_add_u32 v47, s7, v51
v_xor_b32 v47, v50, v47
v_lshlrev_b32 v47, 4, v47
v_add_u32 v5, v46, v47
s_waitcnt lgkmcnt(0)
s_cmp_eq_u32 s82, 0
s_cselect_b32 s8, s36, s48
s_cselect_b32 s9, s37, s49
s_cselect_b32 s16, s38, s50
s_cselect_b32 s17, s39, s51
s_cselect_b32 s20, s40, s52
s_cselect_b32 s21, s41, s53
s_cselect_b32 s12, s42, s54
s_cselect_b32 s13, s43, s55
s_cselect_b32 s24, s44, s56
s_cselect_b32 s25, s45, s57
s_mul_i32 s4, s79, 86016
s_add_u32 s8, s8, s4
s_addc_u32 s9, s9, 0
s_mov_b32 s10, 86016
s_mov_b32 s11, 0x20000
s_lshl_b32 s4, s81, 9
s_add_u32 s12, s12, s4
s_addc_u32 s13, s13, 0
s_sub_u32 s14, 3670016, s4
s_mov_b32 s15, 0x20000
s_mov_b32 s63, s62
s_lshl_b32 s44, s63, 7
s_lshl_b32 s36, s63, 19
s_add_u32 m0, s35, 114688
s_add_u32 s5, s44, 0
buffer_load_dwordx4 v5, s[8:11], s5 offen  lds
s_add_u32 m0, s35, 118784
s_add_u32 s5, s44, 28672
buffer_load_dwordx4 v5, s[8:11], s5 offen  lds
s_add_u32 m0, s35, 122880
s_add_u32 s5, s44, 57344
buffer_load_dwordx4 v5, s[8:11], s5 offen  lds
s_mov_b32 m0, s33
s_add_u32 s5, s36, 0
buffer_load_dwordx4 v4, s[12:15], s5 offen  lds
s_add_u32 m0, s33, 1024
s_add_u32 s5, s36, 65536
buffer_load_dwordx4 v4, s[12:15], s5 offen  lds
s_add_u32 m0, s33, 2048
s_add_u32 s5, s36, 131072
buffer_load_dwordx4 v4, s[12:15], s5 offen  lds
s_add_u32 m0, s33, 3072
s_add_u32 s5, s36, 196608
buffer_load_dwordx4 v4, s[12:15], s5 offen  lds
s_add_u32 s63, s63, 1
s_cmp_eq_u32 s63, 7
s_cselect_b32 s63, 0, s63
s_lshl_b32 s45, s63, 7
s_lshl_b32 s37, s63, 19
s_add_u32 s63, s63, 1
s_cmp_eq_u32 s63, 7
s_cselect_b32 s63, 0, s63
s_lshl_b32 s46, s63, 7
s_lshl_b32 s38, s63, 19
s_add_u32 s63, s63, 1
s_cmp_eq_u32 s63, 7
s_cselect_b32 s63, 0, s63
s_lshl_b32 s47, s63, 7
s_lshl_b32 s39, s63, 19
s_add_u32 s63, s63, 1
s_cmp_eq_u32 s63, 7
s_cselect_b32 s63, 0, s63
s_lshl_b32 s48, s63, 7
s_lshl_b32 s40, s63, 19
s_add_u32 s63, s63, 1
s_cmp_eq_u32 s63, 7
s_cselect_b32 s63, 0, s63
s_lshl_b32 s49, s63, 7
s_lshl_b32 s41, s63, 19
s_add_u32 s63, s63, 1
s_cmp_eq_u32 s63, 7
s_cselect_b32 s63, 0, s63
s_lshl_b32 s50, s63, 7
s_lshl_b32 s42, s63, 19
v_lshrrev_b32 v44, 5, v0
v_lshlrev_b32 v44, 3, v44
v_lshrrev_b32 v45, 2, v52
v_add_u32 v44, v44, v45
v_lshlrev_b32 v44, 7, v44
v_and_b32 v45, 1, v51
v_lshlrev_b32 v45, 1, v45
v_and_b32 v48, 3, v52
v_lshrrev_b32 v48, 1, v48
v_add_u32 v45, v45, v48
v_lshrrev_b32 v48, 3, v52
v_lshlrev_b32 v48, 2, v48
v_xor_b32 v45, v45, v48
v_lshlrev_b32 v45, 4, v45
v_add_u32 v44, v44, v45
v_and_b32 v45, 1, v52
v_lshlrev_b32 v45, 3, v45
v_add_u32 v44, v44, v45
v_add_u32 v8, s33, v44
v_xor_b32 v9, 64, v8
v_add_u32 v38, s34, v44
v_xor_b32 v39, 64, v38
v_and_b32 v44, 31, v0
v_lshrrev_b32 v45, 1, v44
v_and_b32 v45, 7, v45
v_lshrrev_b32 v48, 5, v0
v_xor_b32 v45, v45, v48
v_lshlrev_b32 v45, 4, v45
v_lshlrev_b32 v44, 7, v44
v_add_u32 v44, v44, v45
v_add_u32 v10, 114688, v44
v_xor_b32 v11, 32, v10
v_xor_b32 v12, 64, v10
v_xor_b32 v13, 96, v10
s_add_u32 m0, s33, 4096
s_add_u32 s5, s36, 262144
buffer_load_dwordx4 v4, s[12:15], s5 offen  lds
s_add_u32 m0, s33, 5120
s_add_u32 s5, s36, 327680
buffer_load_dwordx4 v4, s[12:15], s5 offen  lds
s_add_u32 m0, s33, 6144
s_add_u32 s5, s36, 393216
buffer_load_dwordx4 v4, s[12:15], s5 offen  lds
s_add_u32 m0, s33, 7168
s_add_u32 s5, s36, 458752
buffer_load_dwordx4 v4, s[12:15], s5 offen  lds
s_add_u32 m0, s35, 126976
s_add_u32 s5, s45, 0
buffer_load_dwordx4 v5, s[8:11], s5 offen  lds
s_add_u32 m0, s35, 131072
s_add_u32 s5, s45, 28672
buffer_load_dwordx4 v5, s[8:11], s5 offen  lds
s_add_u32 m0, s35, 135168
s_add_u32 s5, s45, 57344
buffer_load_dwordx4 v5, s[8:11], s5 offen  lds
s_add_u32 m0, s33, 32768
s_add_u32 s5, s37, 0
buffer_load_dwordx4 v4, s[12:15], s5 offen  lds
s_add_u32 m0, s33, 33792
s_add_u32 s5, s37, 65536
buffer_load_dwordx4 v4, s[12:15], s5 offen  lds
s_add_u32 m0, s33, 34816
s_add_u32 s5, s37, 131072
buffer_load_dwordx4 v4, s[12:15], s5 offen  lds
s_add_u32 m0, s33, 35840
s_add_u32 s5, s37, 196608
buffer_load_dwordx4 v4, s[12:15], s5 offen  lds
s_waitcnt vmcnt(15)
s_waitcnt vmcnt(11)
s_barrier
ds_read_b64_tr_b16 a[0:1], v8 offset:0
ds_read_b64_tr_b16 a[2:3], v8 offset:512
ds_read_b128 a[8:11], v10 offset:0
ds_read_b64_tr_b16 a[4:5], v9 offset:0
ds_read_b64_tr_b16 a[6:7], v9 offset:512
ds_read_b128 a[12:15], v10 offset:4096
ds_read_b128 a[16:19], v10 offset:8192
ds_read_b64_tr_b16 a[20:21], v8 offset:2048
ds_read_b64_tr_b16 a[22:23], v8 offset:2560
ds_read_b128 a[28:31], v11 offset:0
ds_read_b64_tr_b16 a[24:25], v9 offset:2048
ds_read_b64_tr_b16 a[26:27], v9 offset:2560
ds_read_b128 a[32:35], v11 offset:4096
ds_read_b128 a[36:39], v11 offset:8192
s_waitcnt vmcnt(9)
s_waitcnt lgkmcnt(11)
v_mfma_f32_32x32x16_bf16 v[64:79], a[0:3], a[8:11], 0
ds_read_b64_tr_b16 a[40:41], v8 offset:4096
ds_read_b64_tr_b16 a[42:43], v8 offset:4608
s_waitcnt lgkmcnt(11)
v_mfma_f32_32x32x16_bf16 v[112:127], a[4:7], a[8:11], 0
ds_read_b128 a[48:51], v12 offset:0
ds_read_b64_tr_b16 a[44:45], v9 offset:4096
s_waitcnt lgkmcnt(12)
v_mfma_f32_32x32x16_bf16 v[80:95], a[0:3], a[12:15], 0
ds_read_b64_tr_b16 a[46:47], v9 offset:4608
ds_read_b128 a[52:55], v12 offset:4096
s_add_u32 s16, s16, s61
s_addc_u32 s17, s17, 0
v_mfma_f32_32x32x16_bf16 v[128:143], a[4:7], a[12:15], 0
ds_read_b128 a[56:59], v12 offset:8192
s_mov_b32 s18, 262144
s_add_u32 m0, s33, 36864
s_add_u32 s5, s37, 262144
buffer_load_dwordx4 v4, s[12:15], s5 offen  lds
s_waitcnt lgkmcnt(14)
v_mfma_f32_32x32x16_bf16 v[96:111], a[0:3], a[16:19], 0
s_mov_b32 s19, 0x20000
s_add_u32 m0, s33, 37888
s_add_u32 s5, s37, 327680
buffer_load_dwordx4 v4, s[12:15], s5 offen  lds
v_mfma_f32_32x32x16_bf16 v[144:159], a[4:7], a[16:19], 0
s_add_u32 s20, s20, s61
s_addc_u32 s21, s21, 0
s_waitcnt vmcnt(9)
s_waitcnt lgkmcnt(11)
v_mfma_f32_32x32x16_bf16 v[64:79], a[20:23], a[28:31], v[64:79]
ds_read_b64_tr_b16 a[60:61], v8 offset:6144
ds_read_b64_tr_b16 a[62:63], v8 offset:6656
s_waitcnt lgkmcnt(11)
v_mfma_f32_32x32x16_bf16 v[112:127], a[24:27], a[28:31], v[112:127]
ds_read_b128 a[68:71], v13 offset:0
ds_read_b64_tr_b16 a[64:65], v9 offset:6144
s_waitcnt lgkmcnt(12)
v_mfma_f32_32x32x16_bf16 v[80:95], a[20:23], a[32:35], v[80:95]
ds_read_b64_tr_b16 a[66:67], v9 offset:6656
ds_read_b128 a[72:75], v13 offset:4096
s_mov_b32 s22, 262144
s_add_u32 m0, s33, 38912
s_add_u32 s5, s37, 393216
buffer_load_dwordx4 v4, s[12:15], s5 offen  lds
v_mfma_f32_32x32x16_bf16 v[128:143], a[24:27], a[32:35], v[128:143]
ds_read_b128 a[76:79], v13 offset:8192
s_mov_b32 s23, 0x20000
s_add_u32 m0, s33, 39936
s_add_u32 s5, s37, 458752
buffer_load_dwordx4 v4, s[12:15], s5 offen  lds
s_mul_i32 s4, s81, 229376
s_add_u32 s24, s24, s4
s_addc_u32 s25, s25, 0
s_waitcnt lgkmcnt(14)
v_mfma_f32_32x32x16_bf16 v[96:111], a[20:23], a[36:39], v[96:111]
s_add_u32 m0, s35, 139264
s_add_u32 s5, s46, 0
buffer_load_dwordx4 v5, s[8:11], s5 offen  lds
s_mov_b32 s26, 229376
v_mfma_f32_32x32x16_bf16 v[144:159], a[24:27], a[36:39], v[144:159]
s_add_u32 m0, s35, 143360
s_add_u32 s5, s46, 28672
buffer_load_dwordx4 v5, s[8:11], s5 offen  lds
s_mov_b32 s27, 0x20000
s_add_u32 m0, s35, 147456
s_add_u32 s5, s46, 57344
buffer_load_dwordx4 v5, s[8:11], s5 offen  lds
s_waitcnt vmcnt(9)
s_waitcnt lgkmcnt(0)
s_barrier
v_mfma_f32_32x32x16_bf16 v[64:79], a[40:43], a[48:51], v[64:79]
ds_read_b64_tr_b16 a[0:1], v8 offset:32768
ds_read_b64_tr_b16 a[2:3], v8 offset:33280
v_mfma_f32_32x32x16_bf16 v[112:127], a[44:47], a[48:51], v[112:127]
ds_read_b128 a[8:11], v10 offset:12288
ds_read_b64_tr_b16 a[4:5], v9 offset:32768
v_mfma_f32_32x32x16_bf16 v[80:95], a[40:43], a[52:55], v[80:95]
ds_read_b64_tr_b16 a[6:7], v9 offset:33280
ds_read_b128 a[12:15], v10 offset:16384
s_lshl_b32 s4, s83, 4
s_add_u32 s4, s4, s81
s_mul_i32 s4, s4, 86016
s_add_u32 s28, s58, s4
s_addc_u32 s29, s59, 0
s_mov_b32 m0, s34
s_add_u32 s5, s38, 0
buffer_load_dwordx4 v4, s[12:15], s5 offen  lds
v_mfma_f32_32x32x16_bf16 v[128:143], a[44:47], a[52:55], v[128:143]
ds_read_b128 a[16:19], v10 offset:20480
s_mov_b32 s30, 86016
s_add_u32 m0, s34, 1024
s_add_u32 s5, s38, 65536
buffer_load_dwordx4 v4, s[12:15], s5 offen  lds
v_mfma_f32_32x32x16_bf16 v[96:111], a[40:43], a[56:59], v[96:111]
s_mov_b32 s31, 0x20000
s_add_u32 m0, s35, 114688
s_add_u32 s5, s47, 0
buffer_load_dwordx4 v5, s[8:11], s5 offen  lds
s_add_u32 m0, s35, 118784
s_add_u32 s5, s47, 28672
buffer_load_dwordx4 v5, s[8:11], s5 offen  lds
v_mfma_f32_32x32x16_bf16 v[144:159], a[44:47], a[56:59], v[144:159]
s_mov_b32 s52, s96
s_add_u32 m0, s35, 122880
s_add_u32 s5, s47, 57344
buffer_load_dwordx4 v5, s[8:11], s5 offen  lds
s_waitcnt vmcnt(12)
v_mfma_f32_32x32x16_bf16 v[64:79], a[60:63], a[68:71], v[64:79]
ds_read_b64_tr_b16 a[20:21], v8 offset:34816
ds_read_b64_tr_b16 a[22:23], v8 offset:35328
v_mfma_f32_32x32x16_bf16 v[112:127], a[64:67], a[68:71], v[112:127]
ds_read_b128 a[28:31], v11 offset:12288
ds_read_b64_tr_b16 a[24:25], v9 offset:34816
v_mfma_f32_32x32x16_bf16 v[80:95], a[60:63], a[72:75], v[80:95]
ds_read_b64_tr_b16 a[26:27], v9 offset:35328
ds_read_b128 a[32:35], v11 offset:16384
s_mov_b32 s53, s97
v_mfma_f32_32x32x16_bf16 v[128:143], a[64:67], a[72:75], v[128:143]
ds_read_b128 a[36:39], v11 offset:20480
s_mov_b32 s54, 1376256
s_add_u32 m0, s34, 2048
s_add_u32 s5, s38, 131072
buffer_load_dwordx4 v4, s[12:15], s5 offen  lds
v_mfma_f32_32x32x16_bf16 v[96:111], a[60:63], a[76:79], v[96:111]
s_mov_b32 s55, 0x20000
s_mov_b32 s96, s98
v_mfma_f32_32x32x16_bf16 v[144:159], a[64:67], a[76:79], v[144:159]
s_add_u32 m0, s34, 3072
s_add_u32 s5, s38, 196608
buffer_load_dwordx4 v4, s[12:15], s5 offen  lds
s_mov_b32 s97, s99
s_waitcnt vmcnt(12)
s_waitcnt lgkmcnt(11)
v_mfma_f32_32x32x16_bf16 v[64:79], a[0:3], a[8:11], v[64:79]
ds_read_b64_tr_b16 a[40:41], v8 offset:36864
ds_read_b64_tr_b16 a[42:43], v8 offset:37376
s_waitcnt lgkmcnt(11)
v_mfma_f32_32x32x16_bf16 v[112:127], a[4:7], a[8:11], v[112:127]
ds_read_b128 a[48:51], v12 offset:12288
ds_read_b64_tr_b16 a[44:45], v9 offset:36864
s_waitcnt lgkmcnt(12)
v_mfma_f32_32x32x16_bf16 v[80:95], a[0:3], a[12:15], v[80:95]
ds_read_b64_tr_b16 a[46:47], v9 offset:37376
ds_read_b128 a[52:55], v12 offset:16384
v_lshrrev_b32 v44, 5, v0
v_mfma_f32_32x32x16_bf16 v[128:143], a[4:7], a[12:15], v[128:143]
ds_read_b128 a[56:59], v12 offset:20480
v_and_b32 v45, 31, v0
s_add_u32 m0, s34, 4096
s_add_u32 s5, s38, 262144
buffer_load_dwordx4 v4, s[12:15], s5 offen  lds
s_waitcnt lgkmcnt(14)
v_mfma_f32_32x32x16_bf16 v[96:111], a[0:3], a[16:19], v[96:111]
v_xor_b32 v45, v45, v44
s_add_u32 m0, s34, 5120
s_add_u32 s5, s38, 327680
buffer_load_dwordx4 v4, s[12:15], s5 offen  lds
v_mfma_f32_32x32x16_bf16 v[144:159], a[4:7], a[16:19], v[144:159]
v_lshlrev_b32 v45, 4, v45
s_waitcnt vmcnt(12)
s_waitcnt lgkmcnt(11)
v_mfma_f32_32x32x16_bf16 v[64:79], a[20:23], a[28:31], v[64:79]
ds_read_b64_tr_b16 a[60:61], v8 offset:38912
ds_read_b64_tr_b16 a[62:63], v8 offset:39424
s_waitcnt lgkmcnt(11)
v_mfma_f32_32x32x16_bf16 v[112:127], a[24:27], a[28:31], v[112:127]
ds_read_b128 a[68:71], v13 offset:12288
ds_read_b64_tr_b16 a[64:65], v9 offset:38912
s_waitcnt lgkmcnt(12)
v_mfma_f32_32x32x16_bf16 v[80:95], a[20:23], a[32:35], v[80:95]
ds_read_b64_tr_b16 a[66:67], v9 offset:39424
ds_read_b128 a[72:75], v13 offset:16384
v_lshlrev_b32 v44, 9, v44
s_add_u32 m0, s34, 6144
s_add_u32 s5, s38, 393216
buffer_load_dwordx4 v4, s[12:15], s5 offen  lds
v_mfma_f32_32x32x16_bf16 v[128:143], a[24:27], a[32:35], v[128:143]
ds_read_b128 a[76:79], v13 offset:20480
v_add_u32 v44, v44, v45
s_add_u32 m0, s34, 7168
s_add_u32 s5, s38, 458752
buffer_load_dwordx4 v4, s[12:15], s5 offen  lds
v_add_u32 v1, s33, v44
s_waitcnt lgkmcnt(14)
v_mfma_f32_32x32x16_bf16 v[96:111], a[20:23], a[36:39], v[96:111]
v_xor_b32 v45, v51, v52
s_add_u32 m0, s34, 8192
s_add_u32 s5, s39, 0
buffer_load_dwordx4 v4, s[12:15], s5 offen  lds
v_mfma_f32_32x32x16_bf16 v[144:159], a[24:27], a[36:39], v[144:159]
v_lshlrev_b32 v45, 4, v45
s_add_u32 m0, s34, 9216
s_add_u32 s5, s39, 65536
buffer_load_dwordx4 v4, s[12:15], s5 offen  lds
s_waitcnt vmcnt(11)
s_waitcnt lgkmcnt(0)
s_barrier
v_mfma_f32_32x32x16_bf16 v[64:79], a[40:43], a[48:51], v[64:79]
ds_read_b64_tr_b16 a[0:1], v38 offset:0
ds_read_b64_tr_b16 a[2:3], v38 offset:512
v_mfma_f32_32x32x16_bf16 v[112:127], a[44:47], a[48:51], v[112:127]
ds_read_b128 a[8:11], v10 offset:24576
ds_read_b64_tr_b16 a[4:5], v39 offset:0
v_mfma_f32_32x32x16_bf16 v[80:95], a[40:43], a[52:55], v[80:95]
ds_read_b64_tr_b16 a[6:7], v39 offset:512
ds_read_b128 a[12:15], v10 offset:28672
v_lshlrev_b32 v44, 9, v52
s_add_u32 m0, s34, 10240
s_add_u32 s5, s39, 131072
buffer_load_dwordx4 v4, s[12:15], s5 offen  lds
s_add_u32 m0, s34, 11264
s_add_u32 s5, s39, 196608
buffer_load_dwordx4 v4, s[12:15], s5 offen  lds
v_mfma_f32_32x32x16_bf16 v[128:143], a[44:47], a[52:55], v[128:143]
ds_read_b128 a[16:19], v10 offset:32768
v_add_u32 v44, v44, v45
s_mov_b32 m0, s33
s_add_u32 s5, s39, 262144
buffer_load_dwordx4 v4, s[12:15], s5 offen  lds
v_mfma_f32_32x32x16_bf16 v[96:111], a[40:43], a[56:59], v[96:111]
s_add_u32 m0, s33, 1024
s_add_u32 s5, s39, 327680
buffer_load_dwordx4 v4, s[12:15], s5 offen  lds
v_add_u32 v14, 98304, v44
s_add_u32 m0, s35, 126976
s_add_u32 s5, s48, 0
buffer_load_dwordx4 v5, s[8:11], s5 offen  lds
v_mfma_f32_32x32x16_bf16 v[144:159], a[44:47], a[56:59], v[144:159]
v_xor_b32 v15, 64, v14
s_add_u32 m0, s35, 131072
s_add_u32 s5, s48, 28672
buffer_load_dwordx4 v5, s[8:11], s5 offen  lds
s_add_u32 m0, s35, 135168
s_add_u32 s5, s48, 57344
buffer_load_dwordx4 v5, s[8:11], s5 offen  lds
s_waitcnt vmcnt(13)
v_mfma_f32_32x32x16_bf16 v[64:79], a[60:63], a[68:71], v[64:79]
ds_read_b64_tr_b16 a[20:21], v38 offset:2048
ds_read_b64_tr_b16 a[22:23], v38 offset:2560
v_mfma_f32_32x32x16_bf16 v[112:127], a[64:67], a[68:71], v[112:127]
ds_read_b128 a[28:31], v11 offset:24576
ds_read_b64_tr_b16 a[24:25], v39 offset:2048
v_mfma_f32_32x32x16_bf16 v[80:95], a[60:63], a[72:75], v[80:95]
ds_read_b64_tr_b16 a[26:27], v39 offset:2560
ds_read_b128 a[32:35], v11 offset:28672
v_xor_b32 v16, 128, v14
s_add_u32 m0, s33, 2048
s_add_u32 s5, s39, 393216
buffer_load_dwordx4 v4, s[12:15], s5 offen  lds
v_mfma_f32_32x32x16_bf16 v[128:143], a[64:67], a[72:75], v[128:143]
ds_read_b128 a[36:39], v11 offset:32768
v_xor_b32 v17, 192, v14
s_add_u32 m0, s33, 3072
s_add_u32 s5, s39, 458752
buffer_load_dwordx4 v4, s[12:15], s5 offen  lds
s_lshl_b32 s6, s3, 1
v_lshrrev_b32 v44, 1, v51
v_add_u32 v44, s6, v44
v_mfma_f32_32x32x16_bf16 v[96:111], a[60:63], a[76:79], v[96:111]
v_lshrrev_b32 v45, 1, v52
s_add_u32 m0, s33, 4096
s_add_u32 s5, s40, 0
buffer_load_dwordx4 v4, s[12:15], s5 offen  lds
v_mfma_f32_32x32x16_bf16 v[144:159], a[64:67], a[76:79], v[144:159]
v_xor_b32 v44, v44, v45
s_add_u32 m0, s33, 5120
s_add_u32 s5, s40, 65536
buffer_load_dwordx4 v4, s[12:15], s5 offen  lds
s_waitcnt vmcnt(15)
s_waitcnt lgkmcnt(11)
v_mfma_f32_32x32x16_bf16 v[64:79], a[0:3], a[8:11], v[64:79]
ds_read_b64_tr_b16 a[40:41], v38 offset:4096
ds_read_b64_tr_b16 a[42:43], v38 offset:4608
s_waitcnt lgkmcnt(11)
v_mfma_f32_32x32x16_bf16 v[112:127], a[4:7], a[8:11], v[112:127]
ds_read_b128 a[48:51], v12 offset:24576
ds_read_b64_tr_b16 a[44:45], v39 offset:4096
s_waitcnt lgkmcnt(12)
v_mfma_f32_32x32x16_bf16 v[80:95], a[0:3], a[12:15], v[80:95]
ds_read_b64_tr_b16 a[46:47], v39 offset:4608
ds_read_b128 a[52:55], v12 offset:28672
v_lshlrev_b32 v44, 4, v44
s_add_u32 m0, s33, 6144
s_add_u32 s5, s40, 131072
buffer_load_dwordx4 v4, s[12:15], s5 offen  lds
v_mfma_f32_32x32x16_bf16 v[128:143], a[4:7], a[12:15], v[128:143]
ds_read_b128 a[56:59], v12 offset:32768
v_lshlrev_b32 v45, 7, v52
s_add_u32 m0, s33, 7168
s_add_u32 s5, s40, 196608
buffer_load_dwordx4 v4, s[12:15], s5 offen  lds
s_waitcnt lgkmcnt(14)
v_mfma_f32_32x32x16_bf16 v[96:111], a[0:3], a[16:19], v[96:111]
v_add_u32 v44, v44, v45
s_add_u32 m0, s33, 32768
s_add_u32 s5, s40, 262144
buffer_load_dwordx4 v4, s[12:15], s5 offen  lds
v_mfma_f32_32x32x16_bf16 v[144:159], a[4:7], a[16:19], v[144:159]
v_and_b32 v45, 1, v51
s_add_u32 m0, s33, 33792
s_add_u32 s5, s40, 327680
buffer_load_dwordx4 v4, s[12:15], s5 offen  lds
s_waitcnt vmcnt(17)
s_waitcnt lgkmcnt(11)
v_mfma_f32_32x32x16_bf16 v[64:79], a[20:23], a[28:31], v[64:79]
ds_read_b64_tr_b16 a[60:61], v38 offset:6144
ds_read_b64_tr_b16 a[62:63], v38 offset:6656
s_waitcnt lgkmcnt(11)
v_mfma_f32_32x32x16_bf16 v[112:127], a[24:27], a[28:31], v[112:127]
ds_read_b128 a[68:71], v13 offset:24576
ds_read_b64_tr_b16 a[64:65], v39 offset:6144
s_waitcnt lgkmcnt(12)
v_mfma_f32_32x32x16_bf16 v[80:95], a[20:23], a[32:35], v[80:95]
ds_read_b64_tr_b16 a[66:67], v39 offset:6656
ds_read_b128 a[72:75], v13 offset:28672
v_lshlrev_b32 v45, 3, v45
s_add_u32 m0, s33, 34816
s_add_u32 s5, s40, 393216
buffer_load_dwordx4 v4, s[12:15], s5 offen  lds
v_mfma_f32_32x32x16_bf16 v[128:143], a[24:27], a[32:35], v[128:143]
ds_read_b128 a[76:79], v13 offset:32768
v_add_u32 v44, v44, v45
s_add_u32 m0, s33, 35840
s_add_u32 s5, s40, 458752
buffer_load_dwordx4 v4, s[12:15], s5 offen  lds
v_add_u32 v18, 98304, v44
s_waitcnt lgkmcnt(14)
v_mfma_f32_32x32x16_bf16 v[96:111], a[20:23], a[36:39], v[96:111]
s_lshl_b32 s6, s3, 3
v_xor_b32 v44, s6, v52
s_add_u32 m0, s33, 36864
s_add_u32 s5, s41, 0
buffer_load_dwordx4 v4, s[12:15], s5 offen  lds
v_mfma_f32_32x32x16_bf16 v[144:159], a[24:27], a[36:39], v[144:159]
v_lshlrev_b32 v44, 4, v44
s_add_u32 m0, s33, 37888
s_add_u32 s5, s41, 65536
buffer_load_dwordx4 v4, s[12:15], s5 offen  lds
s_waitcnt vmcnt(19)
s_waitcnt lgkmcnt(0)
s_barrier
v_mfma_f32_32x32x16_bf16 v[64:79], a[40:43], a[48:51], v[64:79]
ds_read_b64_tr_b16 a[0:1], v38 offset:8192
ds_read_b64_tr_b16 a[2:3], v38 offset:8704
v_mfma_f32_32x32x16_bf16 v[112:127], a[44:47], a[48:51], v[112:127]
ds_read_b128 a[8:11], v10 offset:0
ds_read_b64_tr_b16 a[4:5], v39 offset:8192
v_mfma_f32_32x32x16_bf16 v[80:95], a[40:43], a[52:55], v[80:95]
ds_read_b64_tr_b16 a[6:7], v39 offset:8704
ds_read_b128 a[12:15], v10 offset:4096
v_and_b32 v45, 31, v0
s_add_u32 m0, s33, 38912
s_add_u32 s5, s41, 131072
buffer_load_dwordx4 v4, s[12:15], s5 offen  lds
s_add_u32 m0, s33, 39936
s_add_u32 s5, s41, 196608
buffer_load_dwordx4 v4, s[12:15], s5 offen  lds
v_mfma_f32_32x32x16_bf16 v[128:143], a[44:47], a[52:55], v[128:143]
ds_read_b128 a[16:19], v10 offset:8192
v_lshlrev_b32 v45, 9, v45
s_mov_b32 m0, s34
s_add_u32 s5, s41, 262144
buffer_load_dwordx4 v4, s[12:15], s5 offen  lds
v_mfma_f32_32x32x16_bf16 v[96:111], a[40:43], a[56:59], v[96:111]
s_add_u32 m0, s34, 1024
s_add_u32 s5, s41, 327680
buffer_load_dwordx4 v4, s[12:15], s5 offen  lds
v_add_u32 v44, v44, v45
s_add_u32 m0, s35, 139264
s_add_u32 s5, s49, 0
buffer_load_dwordx4 v5, s[8:11], s5 offen  lds
v_mfma_f32_32x32x16_bf16 v[144:159], a[44:47], a[56:59], v[144:159]
v_lshrrev_b32 v45, 5, v0
s_add_u32 m0, s35, 143360
s_add_u32 s5, s49, 28672
buffer_load_dwordx4 v5, s[8:11], s5 offen  lds
s_add_u32 m0, s35, 147456
s_add_u32 s5, s49, 57344
buffer_load_dwordx4 v5, s[8:11], s5 offen  lds
s_waitcnt vmcnt(24)
v_mfma_f32_32x32x16_bf16 v[64:79], a[60:63], a[68:71], v[64:79]
ds_read_b64_tr_b16 a[20:21], v38 offset:10240
ds_read_b64_tr_b16 a[22:23], v38 offset:10752
v_mfma_f32_32x32x16_bf16 v[112:127], a[64:67], a[68:71], v[112:127]
ds_read_b128 a[28:31], v11 offset:0
ds_read_b64_tr_b16 a[24:25], v39 offset:10240
v_mfma_f32_32x32x16_bf16 v[80:95], a[60:63], a[72:75], v[80:95]
ds_read_b64_tr_b16 a[26:27], v39 offset:10752
ds_read_b128 a[32:35], v11 offset:4096
v_lshlrev_b32 v45, 3, v45
v_mfma_f32_32x32x16_bf16 v[128:143], a[64:67], a[72:75], v[128:143]
ds_read_b128 a[36:39], v11 offset:8192
v_add_u32 v44, v44, v45
s_add_u32 m0, s34, 2048
s_add_u32 s5, s41, 393216
buffer_load_dwordx4 v4, s[12:15], s5 offen  lds
v_mfma_f32_32x32x16_bf16 v[96:111], a[60:63], a[76:79], v[96:111]
v_add_u32 v19, 98304, v44
v_lshlrev_b32 v44, 3, v51
v_mfma_f32_32x32x16_bf16 v[144:159], a[64:67], a[76:79], v[144:159]
s_add_u32 m0, s34, 3072
s_add_u32 s5, s41, 458752
buffer_load_dwordx4 v4, s[12:15], s5 offen  lds
v_lshrrev_b32 v45, 2, v52
s_waitcnt vmcnt(24)
s_waitcnt lgkmcnt(11)
v_mfma_f32_32x32x16_bf16 v[64:79], a[0:3], a[8:11], v[64:79]
ds_read_b64_tr_b16 a[40:41], v8 offset:0
ds_read_b64_tr_b16 a[42:43], v8 offset:512
s_waitcnt lgkmcnt(11)
v_mfma_f32_32x32x16_bf16 v[112:127], a[4:7], a[8:11], v[112:127]
ds_read_b128 a[48:51], v12 offset:0
ds_read_b64_tr_b16 a[44:45], v9 offset:0
s_waitcnt lgkmcnt(12)
v_mfma_f32_32x32x16_bf16 v[80:95], a[0:3], a[12:15], v[80:95]
ds_read_b64_tr_b16 a[46:47], v9 offset:512
ds_read_b128 a[52:55], v12 offset:4096
v_add_u32 v44, v44, v45
s_add_u32 m0, s34, 4096
s_add_u32 s5, s42, 0
buffer_load_dwordx4 v4, s[12:15], s5 offen  lds
v_mfma_f32_32x32x16_bf16 v[128:143], a[4:7], a[12:15], v[128:143]
ds_read_b128 a[56:59], v12 offset:8192
v_lshlrev_b32 v44, 7, v44
s_add_u32 m0, s34, 5120
s_add_u32 s5, s42, 65536
buffer_load_dwordx4 v4, s[12:15], s5 offen  lds
s_waitcnt lgkmcnt(14)
v_mfma_f32_32x32x16_bf16 v[96:111], a[0:3], a[16:19], v[96:111]
v_and_b32 v45, 3, v52
v_lshrrev_b32 v45, 1, v45
s_lshl_b32 s6, s3, 1
v_add_u32 v45, s6, v45
s_add_u32 m0, s34, 6144
s_add_u32 s5, s42, 131072
buffer_load_dwordx4 v4, s[12:15], s5 offen  lds
v_mfma_f32_32x32x16_bf16 v[144:159], a[4:7], a[16:19], v[144:159]
v_lshrrev_b32 v48, 3, v52
s_add_u32 m0, s34, 7168
s_add_u32 s5, s42, 196608
buffer_load_dwordx4 v4, s[12:15], s5 offen  lds
s_waitcnt vmcnt(23)
s_waitcnt lgkmcnt(11)
v_mfma_f32_32x32x16_bf16 v[64:79], a[20:23], a[28:31], v[64:79]
ds_read_b64_tr_b16 a[60:61], v8 offset:2048
ds_read_b64_tr_b16 a[62:63], v8 offset:2560
s_waitcnt lgkmcnt(11)
v_mfma_f32_32x32x16_bf16 v[112:127], a[24:27], a[28:31], v[112:127]
ds_read_b128 a[68:71], v13 offset:0
ds_read_b64_tr_b16 a[64:65], v9 offset:2048
s_waitcnt lgkmcnt(12)
v_mfma_f32_32x32x16_bf16 v[80:95], a[20:23], a[32:35], v[80:95]
ds_read_b64_tr_b16 a[66:67], v9 offset:2560
ds_read_b128 a[72:75], v13 offset:4096
v_and_b32 v47, 1, v51
v_mfma_f32_32x32x16_bf16 v[128:143], a[24:27], a[32:35], v[128:143]
ds_read_b128 a[76:79], v13 offset:8192
v_lshlrev_b32 v47, 1, v47
s_add_u32 m0, s34, 8192
s_add_u32 s5, s42, 262144
buffer_load_dwordx4 v4, s[12:15], s5 offen  lds
s_waitcnt lgkmcnt(14)
v_mfma_f32_32x32x16_bf16 v[96:111], a[20:23], a[36:39], v[96:111]
v_or_b32 v48, v48, v47
v_lshlrev_b32 v48, 1, v48
v_mfma_f32_32x32x16_bf16 v[144:159], a[24:27], a[36:39], v[144:159]
s_add_u32 m0, s34, 9216
s_add_u32 s5, s42, 327680
buffer_load_dwordx4 v4, s[12:15], s5 offen  lds
v_xor_b32 v45, v45, v48
s_waitcnt vmcnt(23)
s_waitcnt lgkmcnt(0)
s_barrier
v_mfma_f32_32x32x16_bf16 v[64:79], a[40:43], a[48:51], v[64:79]
ds_read_b64_tr_b16 a[0:1], v8 offset:4096
ds_read_b64_tr_b16 a[2:3], v8 offset:4608
v_mfma_f32_32x32x16_bf16 v[112:127], a[44:47], a[48:51], v[112:127]
ds_read_b128 a[8:11], v10 offset:12288
ds_read_b64_tr_b16 a[4:5], v9 offset:4096
v_mfma_f32_32x32x16_bf16 v[80:95], a[40:43], a[52:55], v[80:95]
ds_read_b64_tr_b16 a[6:7], v9 offset:4608
ds_read_b128 a[12:15], v10 offset:16384
v_lshlrev_b32 v45, 4, v45
s_add_u32 m0, s34, 10240
s_add_u32 s5, s42, 393216
buffer_load_dwordx4 v4, s[12:15], s5 offen  lds
v_mfma_f32_32x32x16_bf16 v[128:143], a[44:47], a[52:55], v[128:143]
ds_read_b128 a[16:19], v10 offset:20480
v_add_u32 v44, v44, v45
s_add_u32 m0, s34, 11264
s_add_u32 s5, s42, 458752
buffer_load_dwordx4 v4, s[12:15], s5 offen  lds
v_mfma_f32_32x32x16_bf16 v[96:111], a[40:43], a[56:59], v[96:111]
v_and_b32 v45, 1, v52
s_add_u32 m0, s35, 114688
s_add_u32 s5, s50, 0
buffer_load_dwordx4 v5, s[8:11], s5 offen  lds
s_add_u32 m0, s35, 118784
s_add_u32 s5, s50, 28672
buffer_load_dwordx4 v5, s[8:11], s5 offen  lds
v_mfma_f32_32x32x16_bf16 v[144:159], a[44:47], a[56:59], v[144:159]
v_lshlrev_b32 v45, 3, v45
s_add_u32 m0, s35, 122880
s_add_u32 s5, s50, 57344
buffer_load_dwordx4 v5, s[8:11], s5 offen  lds
s_waitcnt vmcnt(26)
v_mfma_f32_32x32x16_bf16 v[64:79], a[60:63], a[68:71], v[64:79]
ds_read_b64_tr_b16 a[20:21], v8 offset:6144
ds_read_b64_tr_b16 a[22:23], v8 offset:6656
v_mfma_f32_32x32x16_bf16 v[112:127], a[64:67], a[68:71], v[112:127]
ds_read_b128 a[28:31], v11 offset:12288
ds_read_b64_tr_b16 a[24:25], v9 offset:6144
v_mfma_f32_32x32x16_bf16 v[80:95], a[60:63], a[72:75], v[80:95]
ds_read_b64_tr_b16 a[26:27], v9 offset:6656
ds_read_b128 a[32:35], v11 offset:16384
v_add_u32 v20, v44, v45
v_lshlrev_b32 v44, 4, v52
v_mfma_f32_32x32x16_bf16 v[128:143], a[64:67], a[72:75], v[128:143]
ds_read_b128 a[36:39], v11 offset:20480
v_add_u32 v22, 159744, v44
v_mfma_f32_32x32x16_bf16 v[96:111], a[60:63], a[76:79], v[96:111]
s_lshl_b32 s6, s3, 2
v_add_u32 v21, s6, v22
v_mfma_f32_32x32x16_bf16 v[144:159], a[64:67], a[76:79], v[144:159]
v_lshlrev_b32 v23, 4, v0
s_waitcnt vmcnt(24)
s_waitcnt lgkmcnt(11)
v_mfma_f32_32x32x16_bf16 v[64:79], a[0:3], a[8:11], v[64:79]
ds_read_b64_tr_b16 a[40:41], v8 offset:32768
ds_read_b64_tr_b16 a[42:43], v8 offset:33280
s_waitcnt lgkmcnt(11)
v_mfma_f32_32x32x16_bf16 v[112:127], a[4:7], a[8:11], v[112:127]
ds_read_b128 a[48:51], v12 offset:12288
ds_read_b64_tr_b16 a[44:45], v9 offset:32768
s_waitcnt lgkmcnt(12)
v_mfma_f32_32x32x16_bf16 v[80:95], a[0:3], a[12:15], v[80:95]
ds_read_b64_tr_b16 a[46:47], v9 offset:33280
ds_read_b128 a[52:55], v12 offset:16384
v_mfma_f32_32x32x16_bf16 v[128:143], a[4:7], a[12:15], v[128:143]
ds_read_b128 a[56:59], v12 offset:20480
s_waitcnt lgkmcnt(14)
v_mfma_f32_32x32x16_bf16 v[96:111], a[0:3], a[16:19], v[96:111]
v_mfma_f32_32x32x16_bf16 v[144:159], a[4:7], a[16:19], v[144:159]
s_waitcnt vmcnt(22)
s_waitcnt lgkmcnt(11)
v_mfma_f32_32x32x16_bf16 v[64:79], a[20:23], a[28:31], v[64:79]
ds_read_b64_tr_b16 a[60:61], v8 offset:34816
ds_read_b64_tr_b16 a[62:63], v8 offset:35328
s_waitcnt lgkmcnt(11)
v_mfma_f32_32x32x16_bf16 v[112:127], a[24:27], a[28:31], v[112:127]
ds_read_b128 a[68:71], v13 offset:12288
ds_read_b64_tr_b16 a[64:65], v9 offset:34816
s_waitcnt lgkmcnt(12)
v_mfma_f32_32x32x16_bf16 v[80:95], a[20:23], a[32:35], v[80:95]
ds_read_b64_tr_b16 a[66:67], v9 offset:35328
ds_read_b128 a[72:75], v13 offset:16384
v_xor_b32 v6, 0, v1
s_mov_b32 m0, s33
s_mov_b32 s5, 0
buffer_load_dwordx4 v6, s[16:19], s5 offen nt lds
v_xor_b32 v2, 32, v1
buffer_load_dwordx4 v2, s[16:19], s5 offen offset:1024 nt lds
v_mfma_f32_32x32x16_bf16 v[128:143], a[24:27], a[32:35], v[128:143]
ds_read_b128 a[76:79], v13 offset:20480
v_xor_b32 v6, 64, v1
buffer_load_dwordx4 v6, s[16:19], s5 offen offset:2048 nt lds
s_waitcnt lgkmcnt(14)
v_mfma_f32_32x32x16_bf16 v[96:111], a[20:23], a[36:39], v[96:111]
v_xor_b32 v2, 96, v1
buffer_load_dwordx4 v2, s[16:19], s5 offen offset:3072 nt lds
v_mfma_f32_32x32x16_bf16 v[144:159], a[24:27], a[36:39], v[144:159]
s_or_b32 s4, s2, s3
s_cmp_lg_u32 s4, 0
s_cbranch_scc1 L_nononce
s_memrealtime s[90:91]
s_waitcnt lgkmcnt(0)
s_or_b32 s90, s90, 1
v_mov_b32 v46, s90
v_mov_b32 v47, 0
global_store_dword v47, v46, s[96:97] sc1
L_nononce:
s_waitcnt vmcnt(24)
s_waitcnt vmcnt(17)
s_waitcnt lgkmcnt(0)
s_barrier
v_mfma_f32_32x32x16_bf16 v[64:79], a[40:43], a[48:51], v[64:79]
ds_read_b64_tr_b16 a[0:1], v8 offset:36864
ds_read_b64_tr_b16 a[2:3], v8 offset:37376
v_mfma_f32_32x32x16_bf16 v[112:127], a[44:47], a[48:51], v[112:127]
ds_read_b128 a[8:11], v10 offset:24576
ds_read_b64_tr_b16 a[4:5], v9 offset:36864
v_mfma_f32_32x32x16_bf16 v[80:95], a[40:43], a[52:55], v[80:95]
ds_read_b64_tr_b16 a[6:7], v9 offset:37376
ds_read_b128 a[12:15], v10 offset:28672
v_xor_b32 v6, 128, v1
s_add_u32 m0, s33, 4096
s_mov_b32 s5, 4096
buffer_load_dwordx4 v6, s[16:19], s5 offen nt lds
v_mfma_f32_32x32x16_bf16 v[128:143], a[44:47], a[52:55], v[128:143]
ds_read_b128 a[16:19], v10 offset:32768
v_xor_b32 v2, 160, v1
buffer_load_dwordx4 v2, s[16:19], s5 offen offset:1024 nt lds
v_mfma_f32_32x32x16_bf16 v[96:111], a[40:43], a[56:59], v[96:111]
v_xor_b32 v6, 192, v1
buffer_load_dwordx4 v6, s[16:19], s5 offen offset:2048 nt lds
v_mfma_f32_32x32x16_bf16 v[144:159], a[44:47], a[56:59], v[144:159]
v_mfma_f32_32x32x16_bf16 v[64:79], a[60:63], a[68:71], v[64:79]
ds_read_b64_tr_b16 a[20:21], v8 offset:38912
ds_read_b64_tr_b16 a[22:23], v8 offset:39424
v_mfma_f32_32x32x16_bf16 v[112:127], a[64:67], a[68:71], v[112:127]
ds_read_b128 a[28:31], v11 offset:24576
ds_read_b64_tr_b16 a[24:25], v9 offset:38912
v_mfma_f32_32x32x16_bf16 v[80:95], a[60:63], a[72:75], v[80:95]
ds_read_b64_tr_b16 a[26:27], v9 offset:39424
ds_read_b128 a[32:35], v11 offset:28672
v_mfma_f32_32x32x16_bf16 v[128:143], a[64:67], a[72:75], v[128:143]
ds_read_b128 a[36:39], v11 offset:32768
v_mfma_f32_32x32x16_bf16 v[96:111], a[60:63], a[76:79], v[96:111]
v_mfma_f32_32x32x16_bf16 v[144:159], a[64:67], a[76:79], v[144:159]
s_waitcnt lgkmcnt(11)
v_mfma_f32_32x32x16_bf16 v[64:79], a[0:3], a[8:11], v[64:79]
ds_read_b64_tr_b16 a[40:41], v38 offset:0
ds_read_b64_tr_b16 a[42:43], v38 offset:512
s_waitcnt lgkmcnt(11)
v_mfma_f32_32x32x16_bf16 v[112:127], a[4:7], a[8:11], v[112:127]
ds_read_b128 a[48:51], v12 offset:24576
ds_read_b64_tr_b16 a[44:45], v39 offset:0
s_waitcnt lgkmcnt(12)
v_mfma_f32_32x32x16_bf16 v[80:95], a[0:3], a[12:15], v[80:95]
ds_read_b64_tr_b16 a[46:47], v39 offset:512
ds_read_b128 a[52:55], v12 offset:28672
v_mfma_f32_32x32x16_bf16 v[128:143], a[4:7], a[12:15], v[128:143]
ds_read_b128 a[56:59], v12 offset:32768
s_waitcnt lgkmcnt(14)
v_mfma_f32_32x32x16_bf16 v[96:111], a[0:3], a[16:19], v[96:111]
v_mfma_f32_32x32x16_bf16 v[144:159], a[4:7], a[16:19], v[144:159]
s_waitcnt vmcnt(18)
s_waitcnt lgkmcnt(11)
v_mfma_f32_32x32x16_bf16 v[64:79], a[20:23], a[28:31], v[64:79]
ds_read_b64_tr_b16 a[60:61], v38 offset:2048
ds_read_b64_tr_b16 a[62:63], v38 offset:2560
s_waitcnt lgkmcnt(11)
v_mfma_f32_32x32x16_bf16 v[112:127], a[24:27], a[28:31], v[112:127]
ds_read_b128 a[68:71], v13 offset:24576
ds_read_b64_tr_b16 a[64:65], v39 offset:2048
s_waitcnt lgkmcnt(12)
v_mfma_f32_32x32x16_bf16 v[80:95], a[20:23], a[32:35], v[80:95]
ds_read_b64_tr_b16 a[66:67], v39 offset:2560
ds_read_b128 a[72:75], v13 offset:28672
v_xor_b32 v2, 224, v1
buffer_load_dwordx4 v2, s[16:19], s5 offen offset:3072 nt lds
v_mfma_f32_32x32x16_bf16 v[128:143], a[24:27], a[32:35], v[128:143]
ds_read_b128 a[76:79], v13 offset:32768
v_xor_b32 v6, 0, v1
s_add_u32 m0, s33, 32768
s_mov_b32 s5, 32768
buffer_load_dwordx4 v6, s[16:19], s5 offen nt lds
s_waitcnt lgkmcnt(14)
v_mfma_f32_32x32x16_bf16 v[96:111], a[20:23], a[36:39], v[96:111]
v_xor_b32 v2, 32, v1
buffer_load_dwordx4 v2, s[16:19], s5 offen offset:1024 nt lds
v_mfma_f32_32x32x16_bf16 v[144:159], a[24:27], a[36:39], v[144:159]
v_xor_b32 v6, 64, v1
buffer_load_dwordx4 v6, s[16:19], s5 offen offset:2048 nt lds
s_waitcnt vmcnt(20)
s_waitcnt vmcnt(11)
s_waitcnt lgkmcnt(0)
s_barrier
v_mfma_f32_32x32x16_bf16 v[64:79], a[40:43], a[48:51], v[64:79]
ds_read_b64_tr_b16 a[0:1], v38 offset:4096
ds_read_b64_tr_b16 a[2:3], v38 offset:4608
v_mfma_f32_32x32x16_bf16 v[112:127], a[44:47], a[48:51], v[112:127]
ds_read_b128 a[8:11], v10 offset:0
ds_read_b64_tr_b16 a[4:5], v39 offset:4096
v_mfma_f32_32x32x16_bf16 v[80:95], a[40:43], a[52:55], v[80:95]
ds_read_b64_tr_b16 a[6:7], v39 offset:4608
ds_read_b128 a[12:15], v10 offset:4096
v_xor_b32 v2, 96, v1
buffer_load_dwordx4 v2, s[16:19], s5 offen offset:3072 nt lds
v_mfma_f32_32x32x16_bf16 v[128:143], a[44:47], a[52:55], v[128:143]
ds_read_b128 a[16:19], v10 offset:8192
v_xor_b32 v6, 128, v1
s_add_u32 m0, s33, 36864
s_mov_b32 s5, 36864
buffer_load_dwordx4 v6, s[16:19], s5 offen nt lds
v_mfma_f32_32x32x16_bf16 v[96:111], a[40:43], a[56:59], v[96:111]
v_xor_b32 v2, 160, v1
buffer_load_dwordx4 v2, s[16:19], s5 offen offset:1024 nt lds
v_mfma_f32_32x32x16_bf16 v[144:159], a[44:47], a[56:59], v[144:159]
v_mfma_f32_32x32x16_bf16 v[64:79], a[60:63], a[68:71], v[64:79]
ds_read_b64_tr_b16 a[20:21], v38 offset:6144
ds_read_b64_tr_b16 a[22:23], v38 offset:6656
v_mfma_f32_32x32x16_bf16 v[112:127], a[64:67], a[68:71], v[112:127]
ds_read_b128 a[28:31], v11 offset:0
ds_read_b64_tr_b16 a[24:25], v39 offset:6144
v_mfma_f32_32x32x16_bf16 v[80:95], a[60:63], a[72:75], v[80:95]
ds_read_b64_tr_b16 a[26:27], v39 offset:6656
ds_read_b128 a[32:35], v11 offset:4096
v_mfma_f32_32x32x16_bf16 v[128:143], a[64:67], a[72:75], v[128:143]
ds_read_b128 a[36:39], v11 offset:8192
v_mfma_f32_32x32x16_bf16 v[96:111], a[60:63], a[76:79], v[96:111]
v_mfma_f32_32x32x16_bf16 v[144:159], a[64:67], a[76:79], v[144:159]
s_waitcnt lgkmcnt(11)
v_mfma_f32_32x32x16_bf16 v[64:79], a[0:3], a[8:11], v[64:79]
ds_read_b64_tr_b16 a[40:41], v38 offset:8192
ds_read_b64_tr_b16 a[42:43], v38 offset:8704
s_waitcnt lgkmcnt(11)
v_mfma_f32_32x32x16_bf16 v[112:127], a[4:7], a[8:11], v[112:127]
ds_read_b128 a[48:51], v12 offset:0
ds_read_b64_tr_b16 a[44:45], v39 offset:8192
s_waitcnt lgkmcnt(12)
v_mfma_f32_32x32x16_bf16 v[80:95], a[0:3], a[12:15], v[80:95]
ds_read_b64_tr_b16 a[46:47], v39 offset:8704
ds_read_b128 a[52:55], v12 offset:4096
v_mfma_f32_32x32x16_bf16 v[128:143], a[4:7], a[12:15], v[128:143]
ds_read_b128 a[56:59], v12 offset:8192
s_waitcnt lgkmcnt(14)
v_mfma_f32_32x32x16_bf16 v[96:111], a[0:3], a[16:19], v[96:111]
v_mfma_f32_32x32x16_bf16 v[144:159], a[4:7], a[16:19], v[144:159]
s_waitcnt lgkmcnt(11)
v_mfma_f32_32x32x16_bf16 v[64:79], a[20:23], a[28:31], v[64:79]
ds_read_b64_tr_b16 a[60:61], v38 offset:10240
ds_read_b64_tr_b16 a[62:63], v38 offset:10752
s_waitcnt lgkmcnt(11)
v_mfma_f32_32x32x16_bf16 v[112:127], a[24:27], a[28:31], v[112:127]
ds_read_b128 a[68:71], v13 offset:0
ds_read_b64_tr_b16 a[64:65], v39 offset:10240
s_waitcnt lgkmcnt(12)
v_mfma_f32_32x32x16_bf16 v[80:95], a[20:23], a[32:35], v[80:95]
ds_read_b64_tr_b16 a[66:67], v39 offset:10752
ds_read_b128 a[72:75], v13 offset:4096
v_mfma_f32_32x32x16_bf16 v[128:143], a[24:27], a[32:35], v[128:143]
ds_read_b128 a[76:79], v13 offset:8192
s_waitcnt lgkmcnt(14)
v_mfma_f32_32x32x16_bf16 v[96:111], a[20:23], a[36:39], v[96:111]
v_mfma_f32_32x32x16_bf16 v[144:159], a[24:27], a[36:39], v[144:159]
s_waitcnt lgkmcnt(11)
v_mfma_f32_32x32x16_bf16 v[64:79], a[40:43], a[48:51], v[64:79]
s_waitcnt lgkmcnt(9)
v_mfma_f32_32x32x16_bf16 v[112:127], a[44:47], a[48:51], v[112:127]
s_waitcnt lgkmcnt(8)
v_mfma_f32_32x32x16_bf16 v[80:95], a[40:43], a[52:55], v[80:95]
v_xor_b32 v6, 192, v1
buffer_load_dwordx4 v6, s[16:19], s5 offen offset:2048 nt lds
v_mfma_f32_32x32x16_bf16 v[128:143], a[44:47], a[52:55], v[128:143]
s_waitcnt lgkmcnt(7)
v_mfma_f32_32x32x16_bf16 v[96:111], a[40:43], a[56:59], v[96:111]
v_xor_b32 v2, 224, v1
buffer_load_dwordx4 v2, s[16:19], s5 offen offset:3072 nt lds
v_mfma_f32_32x32x16_bf16 v[144:159], a[44:47], a[56:59], v[144:159]
s_waitcnt lgkmcnt(4)
v_mfma_f32_32x32x16_bf16 v[64:79], a[60:63], a[68:71], v[64:79]
s_waitcnt lgkmcnt(2)
v_mfma_f32_32x32x16_bf16 v[112:127], a[64:67], a[68:71], v[112:127]
s_waitcnt lgkmcnt(1)
v_mfma_f32_32x32x16_bf16 v[80:95], a[60:63], a[72:75], v[80:95]
v_mfma_f32_32x32x16_bf16 v[128:143], a[64:67], a[72:75], v[128:143]
s_waitcnt lgkmcnt(0)
v_mfma_f32_32x32x16_bf16 v[96:111], a[60:63], a[76:79], v[96:111]
v_mfma_f32_32x32x16_bf16 v[144:159], a[64:67], a[76:79], v[144:159]
s_waitcnt lgkmcnt(0)
s_barrier
v_xor_b32 v56, 0, v19
s_nop 0
v_cvt_pk_bf16_f32 v58, v64, v65
v_cvt_pk_bf16_f32 v59, v66, v67
ds_write_b64 v56, v[58:59] offset:0
s_nop 0
v_cvt_pk_bf16_f32 v60, v80, v81
v_cvt_pk_bf16_f32 v61, v82, v83
ds_write_b64 v56, v[60:61] offset:16384
v_cvt_pk_bf16_f32 v62, v96, v97
v_cvt_pk_bf16_f32 v63, v98, v99
ds_write_b64 v56, v[62:63] offset:32768
v_xor_b32 v57, 16, v19
v_cvt_pk_bf16_f32 v58, v68, v69
v_cvt_pk_bf16_f32 v59, v70, v71
ds_write_b64 v57, v[58:59] offset:0
v_cvt_pk_bf16_f32 v60, v84, v85
v_cvt_pk_bf16_f32 v61, v86, v87
ds_write_b64 v57, v[60:61] offset:16384
v_cvt_pk_bf16_f32 v62, v100, v101
v_cvt_pk_bf16_f32 v63, v102, v103
ds_write_b64 v57, v[62:63] offset:32768
v_xor_b32 v56, 32, v19
v_cvt_pk_bf16_f32 v58, v72, v73
v_cvt_pk_bf16_f32 v59, v74, v75
ds_write_b64 v56, v[58:59] offset:0
v_cvt_pk_bf16_f32 v60, v88, v89
v_cvt_pk_bf16_f32 v61, v90, v91
ds_write_b64 v56, v[60:61] offset:16384
v_xor_b32 v6, 0, v1
s_add_u32 m0, s33, 65536
s_mov_b32 s5, 65536
buffer_load_dwordx4 v6, s[16:19], s5 offen nt lds
v_cvt_pk_bf16_f32 v62, v104, v105
v_cvt_pk_bf16_f32 v63, v106, v107
ds_write_b64 v56, v[62:63] offset:32768
v_xor_b32 v57, 48, v19
v_cvt_pk_bf16_f32 v58, v76, v77
v_cvt_pk_bf16_f32 v59, v78, v79
ds_write_b64 v57, v[58:59] offset:0
v_xor_b32 v2, 32, v1
buffer_load_dwordx4 v2, s[16:19], s5 offen offset:1024 nt lds
v_cvt_pk_bf16_f32 v60, v92, v93
v_cvt_pk_bf16_f32 v61, v94, v95
ds_write_b64 v57, v[60:61] offset:16384
v_cvt_pk_bf16_f32 v62, v108, v109
v_cvt_pk_bf16_f32 v63, v110, v111
ds_write_b64 v57, v[62:63] offset:32768
v_xor_b32 v56, 64, v19
v_xor_b32 v6, 64, v1
buffer_load_dwordx4 v6, s[16:19], s5 offen offset:2048 nt lds
v_cvt_pk_bf16_f32 v58, v112, v113
v_cvt_pk_bf16_f32 v59, v114, v115
ds_write_b64 v56, v[58:59] offset:0
v_cvt_pk_bf16_f32 v60, v128, v129
v_cvt_pk_bf16_f32 v61, v130, v131
ds_write_b64 v56, v[60:61] offset:16384
v_xor_b32 v2, 96, v1
buffer_load_dwordx4 v2, s[16:19], s5 offen offset:3072 nt lds
v_cvt_pk_bf16_f32 v62, v144, v145
v_cvt_pk_bf16_f32 v63, v146, v147
ds_write_b64 v56, v[62:63] offset:32768
v_xor_b32 v57, 80, v19
v_cvt_pk_bf16_f32 v58, v116, v117
v_cvt_pk_bf16_f32 v59, v118, v119
ds_write_b64 v57, v[58:59] offset:0
v_xor_b32 v6, 128, v1
s_add_u32 m0, s33, 69632
s_mov_b32 s5, 69632
buffer_load_dwordx4 v6, s[16:19], s5 offen nt lds
v_cvt_pk_bf16_f32 v60, v132, v133
v_cvt_pk_bf16_f32 v61, v134, v135
ds_write_b64 v57, v[60:61] offset:16384
v_cvt_pk_bf16_f32 v62, v148, v149
v_cvt_pk_bf16_f32 v63, v150, v151
ds_write_b64 v57, v[62:63] offset:32768
v_xor_b32 v56, 96, v19
v_xor_b32 v2, 160, v1
buffer_load_dwordx4 v2, s[16:19], s5 offen offset:1024 nt lds
v_cvt_pk_bf16_f32 v58, v120, v121
v_cvt_pk_bf16_f32 v59, v122, v123
ds_write_b64 v56, v[58:59] offset:0
v_cvt_pk_bf16_f32 v60, v136, v137
v_cvt_pk_bf16_f32 v61, v138, v139
ds_write_b64 v56, v[60:61] offset:16384
v_xor_b32 v6, 192, v1
buffer_load_dwordx4 v6, s[16:19], s5 offen offset:2048 nt lds
v_cvt_pk_bf16_f32 v62, v152, v153
v_cvt_pk_bf16_f32 v63, v154, v155
ds_write_b64 v56, v[62:63] offset:32768
v_xor_b32 v57, 112, v19
v_cvt_pk_bf16_f32 v58, v124, v125
v_cvt_pk_bf16_f32 v59, v126, v127
ds_write_b64 v57, v[58:59] offset:0
v_xor_b32 v2, 224, v1
buffer_load_dwordx4 v2, s[16:19], s5 offen offset:3072 nt lds
v_cvt_pk_bf16_f32 v60, v140, v141
v_cvt_pk_bf16_f32 v61, v142, v143
ds_write_b64 v57, v[60:61] offset:16384
v_cvt_pk_bf16_f32 v62, v156, v157
v_cvt_pk_bf16_f32 v63, v158, v159
ds_write_b64 v57, v[62:63] offset:32768
s_waitcnt lgkmcnt(0)
s_barrier
v_add_u32 v41, 3072, v3
v_add_u32 v42, 6144, v3
v_add_u32 v43, 9216, v3
s_add_u32 s4, s33, 4294868992
v_add_u32 v52, s4, v14
v_add_u32 v53, s4, v15
v_add_u32 v54, s4, v16
v_add_u32 v55, s4, v17
s_waitcnt vmcnt(16)
ds_read_b128 a[192:195], v52 offset:0
ds_read_b128 a[0:3], v14 offset:0
ds_read_b128 a[4:7], v14 offset:8192
ds_read_b128 a[8:11], v14 offset:16384
ds_read_b128 a[12:15], v14 offset:24576
ds_read_b128 a[16:19], v14 offset:32768
ds_read_b128 a[20:23], v14 offset:40960
s_waitcnt lgkmcnt(5)
v_mfma_f32_16x16x32_bf16 v[64:67], a[192:195], a[0:3], 0
ds_read_b128 a[196:199], v53 offset:0
ds_read_b128 a[24:27], v15 offset:0
s_waitcnt lgkmcnt(6)
v_mfma_f32_16x16x32_bf16 v[68:71], a[192:195], a[4:7], 0
ds_read_b128 a[28:31], v15 offset:8192
s_waitcnt lgkmcnt(6)
v_mfma_f32_16x16x32_bf16 v[72:75], a[192:195], a[8:11], 0
ds_read_b128 a[32:35], v15 offset:16384
s_waitcnt lgkmcnt(6)
v_mfma_f32_16x16x32_bf16 v[76:79], a[192:195], a[12:15], 0
ds_read_b128 a[36:39], v15 offset:24576
s_waitcnt lgkmcnt(6)
v_mfma_f32_16x16x32_bf16 v[80:83], a[192:195], a[16:19], 0
ds_read_b128 a[40:43], v15 offset:32768
s_waitcnt lgkmcnt(6)
v_mfma_f32_16x16x32_bf16 v[84:87], a[192:195], a[20:23], 0
ds_read_b128 a[44:47], v15 offset:40960
s_waitcnt lgkmcnt(5)
v_mfma_f32_16x16x32_bf16 v[64:67], a[196:199], a[24:27], v[64:67]
ds_read_b128 a[200:203], v54 offset:0
ds_read_b128 a[48:51], v16 offset:0
s_waitcnt lgkmcnt(6)
v_mfma_f32_16x16x32_bf16 v[68:71], a[196:199], a[28:31], v[68:71]
ds_read_b128 a[52:55], v16 offset:8192
s_waitcnt lgkmcnt(6)
v_mfma_f32_16x16x32_bf16 v[72:75], a[196:199], a[32:35], v[72:75]
ds_read_b128 a[56:59], v16 offset:16384
s_waitcnt lgkmcnt(6)
v_mfma_f32_16x16x32_bf16 v[76:79], a[196:199], a[36:39], v[76:79]
ds_read_b128 a[60:63], v16 offset:24576
s_waitcnt lgkmcnt(6)
v_mfma_f32_16x16x32_bf16 v[80:83], a[196:199], a[40:43], v[80:83]
ds_read_b128 a[64:67], v16 offset:32768
s_waitcnt lgkmcnt(6)
v_mfma_f32_16x16x32_bf16 v[84:87], a[196:199], a[44:47], v[84:87]
ds_read_b128 a[68:71], v16 offset:40960
s_waitcnt lgkmcnt(5)
v_mfma_f32_16x16x32_bf16 v[64:67], a[200:203], a[48:51], v[64:67]
ds_read_b128 a[204:207], v55 offset:0
ds_read_b128 a[72:75], v17 offset:0
s_waitcnt lgkmcnt(6)
v_mfma_f32_16x16x32_bf16 v[68:71], a[200:203], a[52:55], v[68:71]
ds_read_b128 a[76:79], v17 offset:8192
s_waitcnt lgkmcnt(6)
v_mfma_f32_16x16x32_bf16 v[72:75], a[200:203], a[56:59], v[72:75]
ds_read_b128 a[80:83], v17 offset:16384
s_waitcnt lgkmcnt(6)
v_mfma_f32_16x16x32_bf16 v[76:79], a[200:203], a[60:63], v[76:79]
ds_read_b128 a[84:87], v17 offset:24576
s_waitcnt lgkmcnt(6)
v_mfma_f32_16x16x32_bf16 v[80:83], a[200:203], a[64:67], v[80:83]
ds_read_b128 a[88:91], v17 offset:32768
s_waitcnt lgkmcnt(6)
v_mfma_f32_16x16x32_bf16 v[84:87], a[200:203], a[68:71], v[84:87]
ds_read_b128 a[92:95], v17 offset:40960
s_waitcnt lgkmcnt(5)
v_mfma_f32_16x16x32_bf16 v[64:67], a[204:207], a[72:75], v[64:67]
ds_read_b128 a[208:211], v52 offset:256
ds_read_b128 a[96:99], v14 offset:256
s_waitcnt lgkmcnt(6)
v_mfma_f32_16x16x32_bf16 v[68:71], a[204:207], a[76:79], v[68:71]
ds_read_b128 a[100:103], v14 offset:8448
s_waitcnt lgkmcnt(6)
v_mfma_f32_16x16x32_bf16 v[72:75], a[204:207], a[80:83], v[72:75]
ds_read_b128 a[104:107], v14 offset:16640
s_waitcnt lgkmcnt(6)
v_mfma_f32_16x16x32_bf16 v[76:79], a[204:207], a[84:87], v[76:79]
ds_read_b128 a[108:111], v14 offset:24832
s_waitcnt lgkmcnt(6)
v_mfma_f32_16x16x32_bf16 v[80:83], a[204:207], a[88:91], v[80:83]
ds_read_b128 a[112:115], v14 offset:33024
s_waitcnt lgkmcnt(6)
v_mfma_f32_16x16x32_bf16 v[84:87], a[204:207], a[92:95], v[84:87]
ds_read_b128 a[116:119], v14 offset:41216
s_waitcnt lgkmcnt(5)
v_mfma_f32_16x16x32_bf16 v[64:67], a[208:211], a[96:99], v[64:67]
ds_read_b128 a[212:215], v53 offset:256
ds_read_b128 a[120:123], v15 offset:256
s_waitcnt lgkmcnt(6)
v_mfma_f32_16x16x32_bf16 v[68:71], a[208:211], a[100:103], v[68:71]
ds_read_b128 a[124:127], v15 offset:8448
s_waitcnt lgkmcnt(6)
v_mfma_f32_16x16x32_bf16 v[72:75], a[208:211], a[104:107], v[72:75]
ds_read_b128 a[128:131], v15 offset:16640
s_waitcnt lgkmcnt(6)
v_mfma_f32_16x16x32_bf16 v[76:79], a[208:211], a[108:111], v[76:79]
ds_read_b128 a[132:135], v15 offset:24832
s_waitcnt lgkmcnt(6)
v_mfma_f32_16x16x32_bf16 v[80:83], a[208:211], a[112:115], v[80:83]
ds_read_b128 a[136:139], v15 offset:33024
s_waitcnt lgkmcnt(6)
v_mfma_f32_16x16x32_bf16 v[84:87], a[208:211], a[116:119], v[84:87]
ds_read_b128 a[140:143], v15 offset:41216
s_waitcnt lgkmcnt(5)
v_mfma_f32_16x16x32_bf16 v[64:67], a[212:215], a[120:123], v[64:67]
ds_read_b128 a[216:219], v54 offset:256
ds_read_b128 a[144:147], v16 offset:256
s_waitcnt lgkmcnt(6)
v_mfma_f32_16x16x32_bf16 v[68:71], a[212:215], a[124:127], v[68:71]
ds_read_b128 a[148:151], v16 offset:8448
s_waitcnt lgkmcnt(6)
v_mfma_f32_16x16x32_bf16 v[72:75], a[212:215], a[128:131], v[72:75]
ds_read_b128 a[152:155], v16 offset:16640
s_waitcnt lgkmcnt(6)
v_mfma_f32_16x16x32_bf16 v[76:79], a[212:215], a[132:135], v[76:79]
ds_read_b128 a[156:159], v16 offset:24832
s_waitcnt lgkmcnt(6)
v_mfma_f32_16x16x32_bf16 v[80:83], a[212:215], a[136:139], v[80:83]
ds_read_b128 a[160:163], v16 offset:33024
s_waitcnt lgkmcnt(6)
v_mfma_f32_16x16x32_bf16 v[84:87], a[212:215], a[140:143], v[84:87]
ds_read_b128 a[164:167], v16 offset:41216
s_waitcnt lgkmcnt(5)
v_mfma_f32_16x16x32_bf16 v[64:67], a[216:219], a[144:147], v[64:67]
ds_read_b128 a[220:223], v55 offset:256
ds_read_b128 a[168:171], v17 offset:256
s_waitcnt lgkmcnt(6)
v_mfma_f32_16x16x32_bf16 v[68:71], a[216:219], a[148:151], v[68:71]
ds_read_b128 a[172:175], v17 offset:8448
s_waitcnt lgkmcnt(6)
v_mfma_f32_16x16x32_bf16 v[72:75], a[216:219], a[152:155], v[72:75]
ds_read_b128 a[176:179], v17 offset:16640
s_waitcnt lgkmcnt(6)
v_mfma_f32_16x16x32_bf16 v[76:79], a[216:219], a[156:159], v[76:79]
ds_read_b128 a[180:183], v17 offset:24832
s_waitcnt lgkmcnt(6)
v_mfma_f32_16x16x32_bf16 v[80:83], a[216:219], a[160:163], v[80:83]
ds_read_b128 a[184:187], v17 offset:33024
s_waitcnt lgkmcnt(6)
v_mfma_f32_16x16x32_bf16 v[84:87], a[216:219], a[164:167], v[84:87]
ds_read_b128 a[188:191], v17 offset:41216
s_waitcnt lgkmcnt(5)
v_mfma_f32_16x16x32_bf16 v[64:67], a[220:223], a[168:171], v[64:67]
s_waitcnt lgkmcnt(4)
v_mfma_f32_16x16x32_bf16 v[68:71], a[220:223], a[172:175], v[68:71]
s_waitcnt lgkmcnt(3)
v_mfma_f32_16x16x32_bf16 v[72:75], a[220:223], a[176:179], v[72:75]
s_waitcnt lgkmcnt(2)
v_mfma_f32_16x16x32_bf16 v[76:79], a[220:223], a[180:183], v[76:79]
s_waitcnt lgkmcnt(1)
v_mfma_f32_16x16x32_bf16 v[80:83], a[220:223], a[184:187], v[80:83]
s_waitcnt lgkmcnt(0)
v_mfma_f32_16x16x32_bf16 v[84:87], a[220:223], a[188:191], v[84:87]
s_add_u32 s4, s33, 4294901760
v_add_u32 v52, s4, v14
v_add_u32 v53, s4, v15
v_add_u32 v54, s4, v16
v_add_u32 v55, s4, v17
s_waitcnt vmcnt(8)
ds_read_b128 a[224:227], v52 offset:0
ds_read_b128 a[228:231], v53 offset:0
ds_read_b128 a[232:235], v54 offset:0
ds_read_b128 a[236:239], v55 offset:0
ds_read_b128 a[240:243], v52 offset:256
ds_read_b128 a[244:247], v53 offset:256
ds_read_b128 a[248:251], v54 offset:256
ds_read_b128 a[252:255], v55 offset:256
s_waitcnt lgkmcnt(7)
v_mfma_f32_16x16x32_bf16 v[88:91], a[224:227], a[0:3], 0
v_mfma_f32_16x16x32_bf16 v[92:95], a[224:227], a[4:7], 0
v_mfma_f32_16x16x32_bf16 v[96:99], a[224:227], a[8:11], 0
v_mul_f32 v64, s32, v64
v_mfma_f32_16x16x32_bf16 v[100:103], a[224:227], a[12:15], 0
v_mfma_f32_16x16x32_bf16 v[104:107], a[224:227], a[16:19], 0
v_mul_f32 v65, s32, v65
v_mfma_f32_16x16x32_bf16 v[108:111], a[224:227], a[20:23], 0
v_mul_f32 v66, s32, v66
s_waitcnt lgkmcnt(6)
v_mfma_f32_16x16x32_bf16 v[88:91], a[228:231], a[24:27], v[88:91]
v_mul_f32 v67, s32, v67
v_mfma_f32_16x16x32_bf16 v[92:95], a[228:231], a[28:31], v[92:95]
v_max3_f32 v24, v64, v65, v66
v_mfma_f32_16x16x32_bf16 v[96:99], a[228:231], a[32:35], v[96:99]
v_xor_b32 v6, 0, v1
s_mov_b32 m0, s33
s_mov_b32 s5, 98304
buffer_load_dwordx4 v6, s[16:19], s5 offen nt lds
v_mfma_f32_16x16x32_bf16 v[100:103], a[228:231], a[36:39], v[100:103]
v_max_f32 v24, v24, v67
v_mfma_f32_16x16x32_bf16 v[104:107], a[228:231], a[40:43], v[104:107]
v_mul_f32 v68, s32, v68
v_mfma_f32_16x16x32_bf16 v[108:111], a[228:231], a[44:47], v[108:111]
v_mul_f32 v69, s32, v69
s_waitcnt lgkmcnt(5)
v_mfma_f32_16x16x32_bf16 v[88:91], a[232:235], a[48:51], v[88:91]
v_mul_f32 v70, s32, v70
v_mfma_f32_16x16x32_bf16 v[92:95], a[232:235], a[52:55], v[92:95]
v_xor_b32 v2, 32, v1
buffer_load_dwordx4 v2, s[16:19], s5 offen offset:1024 nt lds
v_mfma_f32_16x16x32_bf16 v[96:99], a[232:235], a[56:59], v[96:99]
v_mul_f32 v71, s32, v71
v_mfma_f32_16x16x32_bf16 v[100:103], a[232:235], a[60:63], v[100:103]
v_max3_f32 v25, v68, v69, v70
v_mfma_f32_16x16x32_bf16 v[104:107], a[232:235], a[64:67], v[104:107]
v_max_f32 v25, v25, v71
v_mfma_f32_16x16x32_bf16 v[108:111], a[232:235], a[68:71], v[108:111]
v_mul_f32 v72, s32, v72
s_waitcnt lgkmcnt(4)
v_mfma_f32_16x16x32_bf16 v[88:91], a[236:239], a[72:75], v[88:91]
v_xor_b32 v6, 64, v1
buffer_load_dwordx4 v6, s[16:19], s5 offen offset:2048 nt lds
v_mfma_f32_16x16x32_bf16 v[92:95], a[236:239], a[76:79], v[92:95]
v_mul_f32 v73, s32, v73
v_mfma_f32_16x16x32_bf16 v[96:99], a[236:239], a[80:83], v[96:99]
v_mul_f32 v74, s32, v74
v_mfma_f32_16x16x32_bf16 v[100:103], a[236:239], a[84:87], v[100:103]
v_mul_f32 v75, s32, v75
v_mfma_f32_16x16x32_bf16 v[104:107], a[236:239], a[88:91], v[104:107]
v_max3_f32 v26, v72, v73, v74
v_mfma_f32_16x16x32_bf16 v[108:111], a[236:239], a[92:95], v[108:111]
v_xor_b32 v2, 96, v1
buffer_load_dwordx4 v2, s[16:19], s5 offen offset:3072 nt lds
s_waitcnt lgkmcnt(3)
v_mfma_f32_16x16x32_bf16 v[88:91], a[240:243], a[96:99], v[88:91]
v_max_f32 v26, v26, v75
v_mfma_f32_16x16x32_bf16 v[92:95], a[240:243], a[100:103], v[92:95]
v_mul_f32 v76, s32, v76
v_mfma_f32_16x16x32_bf16 v[96:99], a[240:243], a[104:107], v[96:99]
v_mul_f32 v77, s32, v77
v_mfma_f32_16x16x32_bf16 v[100:103], a[240:243], a[108:111], v[100:103]
v_mul_f32 v78, s32, v78
v_mfma_f32_16x16x32_bf16 v[104:107], a[240:243], a[112:115], v[104:107]
v_xor_b32 v6, 128, v1
s_add_u32 m0, s33, 4096
s_mov_b32 s5, 102400
buffer_load_dwordx4 v6, s[16:19], s5 offen nt lds
v_mfma_f32_16x16x32_bf16 v[108:111], a[240:243], a[116:119], v[108:111]
v_mul_f32 v79, s32, v79
s_waitcnt lgkmcnt(2)
v_mfma_f32_16x16x32_bf16 v[88:91], a[244:247], a[120:123], v[88:91]
v_max3_f32 v27, v76, v77, v78
v_mfma_f32_16x16x32_bf16 v[92:95], a[244:247], a[124:127], v[92:95]
v_max_f32 v27, v27, v79
v_mfma_f32_16x16x32_bf16 v[96:99], a[244:247], a[128:131], v[96:99]
v_mul_f32 v80, s32, v80
v_mfma_f32_16x16x32_bf16 v[100:103], a[244:247], a[132:135], v[100:103]
v_xor_b32 v2, 160, v1
buffer_load_dwordx4 v2, s[16:19], s5 offen offset:1024 nt lds
v_mfma_f32_16x16x32_bf16 v[104:107], a[244:247], a[136:139], v[104:107]
v_mul_f32 v81, s32, v81
v_mfma_f32_16x16x32_bf16 v[108:111], a[244:247], a[140:143], v[108:111]
v_mul_f32 v82, s32, v82
s_waitcnt lgkmcnt(1)
v_mfma_f32_16x16x32_bf16 v[88:91], a[248:251], a[144:147], v[88:91]
v_mul_f32 v83, s32, v83
v_mfma_f32_16x16x32_bf16 v[92:95], a[248:251], a[148:151], v[92:95]
v_max3_f32 v28, v80, v81, v82
v_mfma_f32_16x16x32_bf16 v[96:99], a[248:251], a[152:155], v[96:99]
v_xor_b32 v6, 192, v1
buffer_load_dwordx4 v6, s[16:19], s5 offen offset:2048 nt lds
v_mfma_f32_16x16x32_bf16 v[100:103], a[248:251], a[156:159], v[100:103]
v_max_f32 v28, v28, v83
v_mfma_f32_16x16x32_bf16 v[104:107], a[248:251], a[160:163], v[104:107]
v_mul_f32 v84, s32, v84
v_mfma_f32_16x16x32_bf16 v[108:111], a[248:251], a[164:167], v[108:111]
v_mul_f32 v85, s32, v85
s_waitcnt lgkmcnt(0)
v_mfma_f32_16x16x32_bf16 v[88:91], a[252:255], a[168:171], v[88:91]
v_mul_f32 v86, s32, v86
v_mfma_f32_16x16x32_bf16 v[92:95], a[252:255], a[172:175], v[92:95]
v_xor_b32 v2, 224, v1
buffer_load_dwordx4 v2, s[16:19], s5 offen offset:3072 nt lds
v_mfma_f32_16x16x32_bf16 v[96:99], a[252:255], a[176:179], v[96:99]
v_mul_f32 v87, s32, v87
v_mfma_f32_16x16x32_bf16 v[100:103], a[252:255], a[180:183], v[100:103]
v_max3_f32 v29, v84, v85, v86
v_mfma_f32_16x16x32_bf16 v[104:107], a[252:255], a[184:187], v[104:107]
v_max_f32 v29, v29, v87
v_mfma_f32_16x16x32_bf16 v[108:111], a[252:255], a[188:191], v[108:111]
s_add_u32 s4, s33, 4294934528
v_add_u32 v52, s4, v14
v_add_u32 v53, s4, v15
v_add_u32 v54, s4, v16
v_add_u32 v55, s4, v17
s_waitcnt vmcnt(8)
ds_read_b128 a[192:195], v52 offset:0
ds_read_b128 a[196:199], v53 offset:0
ds_read_b128 a[200:203], v54 offset:0
ds_read_b128 a[204:207], v55 offset:0
ds_read_b128 a[208:211], v52 offset:256
ds_read_b128 a[212:215], v53 offset:256
ds_read_b128 a[216:219], v54 offset:256
ds_read_b128 a[220:223], v55 offset:256
s_waitcnt lgkmcnt(7)
v_mfma_f32_16x16x32_bf16 v[112:115], a[192:195], a[0:3], 0
v_mfma_f32_16x16x32_bf16 v[116:119], a[192:195], a[4:7], 0
v_mfma_f32_16x16x32_bf16 v[120:123], a[192:195], a[8:11], 0
v_mul_f32 v88, s32, v88
v_mfma_f32_16x16x32_bf16 v[124:127], a[192:195], a[12:15], 0
v_mfma_f32_16x16x32_bf16 v[128:131], a[192:195], a[16:19], 0
v_mul_f32 v89, s32, v89
v_mfma_f32_16x16x32_bf16 v[132:135], a[192:195], a[20:23], 0
v_mul_f32 v90, s32, v90
s_waitcnt lgkmcnt(6)
v_mfma_f32_16x16x32_bf16 v[112:115], a[196:199], a[24:27], v[112:115]
v_mul_f32 v91, s32, v91
v_mfma_f32_16x16x32_bf16 v[116:119], a[196:199], a[28:31], v[116:119]
v_max3_f32 v24, v24, v88, v89
v_mfma_f32_16x16x32_bf16 v[120:123], a[196:199], a[32:35], v[120:123]
v_xor_b32 v6, 0, v1
s_add_u32 m0, s33, 32768
s_mov_b32 s5, 131072
buffer_load_dwordx4 v6, s[16:19], s5 offen nt lds
v_mfma_f32_16x16x32_bf16 v[124:127], a[196:199], a[36:39], v[124:127]
v_max3_f32 v24, v24, v90, v91
v_mfma_f32_16x16x32_bf16 v[128:131], a[196:199], a[40:43], v[128:131]
v_mul_f32 v92, s32, v92
v_mfma_f32_16x16x32_bf16 v[132:135], a[196:199], a[44:47], v[132:135]
v_mul_f32 v93, s32, v93
s_waitcnt lgkmcnt(5)
v_mfma_f32_16x16x32_bf16 v[112:115], a[200:203], a[48:51], v[112:115]
v_mul_f32 v94, s32, v94
v_mfma_f32_16x16x32_bf16 v[116:119], a[200:203], a[52:55], v[116:119]
v_xor_b32 v2, 32, v1
buffer_load_dwordx4 v2, s[16:19], s5 offen offset:1024 nt lds
v_mfma_f32_16x16x32_bf16 v[120:123], a[200:203], a[56:59], v[120:123]
v_mul_f32 v95, s32, v95
v_mfma_f32_16x16x32_bf16 v[124:127], a[200:203], a[60:63], v[124:127]
v_max3_f32 v25, v25, v92, v93
v_mfma_f32_16x16x32_bf16 v[128:131], a[200:203], a[64:67], v[128:131]
v_max3_f32 v25, v25, v94, v95
v_mfma_f32_16x16x32_bf16 v[132:135], a[200:203], a[68:71], v[132:135]
v_mul_f32 v96, s32, v96
s_waitcnt lgkmcnt(4)
v_mfma_f32_16x16x32_bf16 v[112:115], a[204:207], a[72:75], v[112:115]
v_xor_b32 v6, 64, v1
buffer_load_dwordx4 v6, s[16:19], s5 offen offset:2048 nt lds
v_mfma_f32_16x16x32_bf16 v[116:119], a[204:207], a[76:79], v[116:119]
v_mul_f32 v97, s32, v97
v_mfma_f32_16x16x32_bf16 v[120:123], a[204:207], a[80:83], v[120:123]
v_mul_f32 v98, s32, v98
v_mfma_f32_16x16x32_bf16 v[124:127], a[204:207], a[84:87], v[124:127]
v_mul_f32 v99, s32, v99
v_mfma_f32_16x16x32_bf16 v[128:131], a[204:207], a[88:91], v[128:131]
v_max3_f32 v26, v26, v96, v97
v_mfma_f32_16x16x32_bf16 v[132:135], a[204:207], a[92:95], v[132:135]
v_xor_b32 v2, 96, v1
buffer_load_dwordx4 v2, s[16:19], s5 offen offset:3072 nt lds
s_waitcnt lgkmcnt(3)
v_mfma_f32_16x16x32_bf16 v[112:115], a[208:211], a[96:99], v[112:115]
v_max3_f32 v26, v26, v98, v99
v_mfma_f32_16x16x32_bf16 v[116:119], a[208:211], a[100:103], v[116:119]
v_mul_f32 v100, s32, v100
v_mfma_f32_16x16x32_bf16 v[120:123], a[208:211], a[104:107], v[120:123]
v_mul_f32 v101, s32, v101
v_mfma_f32_16x16x32_bf16 v[124:127], a[208:211], a[108:111], v[124:127]
v_mul_f32 v102, s32, v102
v_mfma_f32_16x16x32_bf16 v[128:131], a[208:211], a[112:115], v[128:131]
v_xor_b32 v6, 128, v1
s_add_u32 m0, s33, 36864
s_mov_b32 s5, 135168
buffer_load_dwordx4 v6, s[16:19], s5 offen nt lds
v_mfma_f32_16x16x32_bf16 v[132:135], a[208:211], a[116:119], v[132:135]
v_mul_f32 v103, s32, v103
s_waitcnt lgkmcnt(2)
v_mfma_f32_16x16x32_bf16 v[112:115], a[212:215], a[120:123], v[112:115]
v_max3_f32 v27, v27, v100, v101
v_mfma_f32_16x16x32_bf16 v[116:119], a[212:215], a[124:127], v[116:119]
v_max3_f32 v27, v27, v102, v103
v_mfma_f32_16x16x32_bf16 v[120:123], a[212:215], a[128:131], v[120:123]
v_mul_f32 v104, s32, v104
v_mfma_f32_16x16x32_bf16 v[124:127], a[212:215], a[132:135], v[124:127]
v_xor_b32 v2, 160, v1
buffer_load_dwordx4 v2, s[16:19], s5 offen offset:1024 nt lds
v_mfma_f32_16x16x32_bf16 v[128:131], a[212:215], a[136:139], v[128:131]
v_mul_f32 v105, s32, v105
v_mfma_f32_16x16x32_bf16 v[132:135], a[212:215], a[140:143], v[132:135]
v_mul_f32 v106, s32, v106
s_waitcnt lgkmcnt(1)
v_mfma_f32_16x16x32_bf16 v[112:115], a[216:219], a[144:147], v[112:115]
v_mul_f32 v107, s32, v107
v_mfma_f32_16x16x32_bf16 v[116:119], a[216:219], a[148:151], v[116:119]
v_max3_f32 v28, v28, v104, v105
v_mfma_f32_16x16x32_bf16 v[120:123], a[216:219], a[152:155], v[120:123]
v_xor_b32 v6, 192, v1
buffer_load_dwordx4 v6, s[16:19], s5 offen offset:2048 nt lds
v_mfma_f32_16x16x32_bf16 v[124:127], a[216:219], a[156:159], v[124:127]
v_max3_f32 v28, v28, v106, v107
v_mfma_f32_16x16x32_bf16 v[128:131], a[216:219], a[160:163], v[128:131]
v_mul_f32 v108, s32, v108
v_mfma_f32_16x16x32_bf16 v[132:135], a[216:219], a[164:167], v[132:135]
v_mul_f32 v109, s32, v109
s_waitcnt lgkmcnt(0)
v_mfma_f32_16x16x32_bf16 v[112:115], a[220:223], a[168:171], v[112:115]
v_mul_f32 v110, s32, v110
v_mfma_f32_16x16x32_bf16 v[116:119], a[220:223], a[172:175], v[116:119]
v_xor_b32 v2, 224, v1
buffer_load_dwordx4 v2, s[16:19], s5 offen offset:3072 nt lds
v_mfma_f32_16x16x32_bf16 v[120:123], a[220:223], a[176:179], v[120:123]
v_mul_f32 v111, s32, v111
v_mfma_f32_16x16x32_bf16 v[124:127], a[220:223], a[180:183], v[124:127]
v_max3_f32 v29, v29, v108, v109
v_mfma_f32_16x16x32_bf16 v[128:131], a[220:223], a[184:187], v[128:131]
v_max3_f32 v29, v29, v110, v111
v_mfma_f32_16x16x32_bf16 v[132:135], a[220:223], a[188:191], v[132:135]
s_add_u32 s4, s33, 4294868992
v_add_u32 v52, s4, v14
v_add_u32 v53, s4, v15
v_add_u32 v54, s4, v16
v_add_u32 v55, s4, v17
s_waitcnt vmcnt(8)
ds_read_b128 a[224:227], v52 offset:0
ds_read_b128 a[228:231], v53 offset:0
ds_read_b128 a[232:235], v54 offset:0
ds_read_b128 a[236:239], v55 offset:0
ds_read_b128 a[240:243], v52 offset:256
ds_read_b128 a[244:247], v53 offset:256
ds_read_b128 a[248:251], v54 offset:256
ds_read_b128 a[252:255], v55 offset:256
s_waitcnt lgkmcnt(7)
v_mfma_f32_16x16x32_bf16 v[136:139], a[224:227], a[0:3], 0
v_mfma_f32_16x16x32_bf16 v[140:143], a[224:227], a[4:7], 0
v_mfma_f32_16x16x32_bf16 v[144:147], a[224:227], a[8:11], 0
v_mul_f32 v112, s32, v112
v_mfma_f32_16x16x32_bf16 v[148:151], a[224:227], a[12:15], 0
v_mfma_f32_16x16x32_bf16 v[152:155], a[224:227], a[16:19], 0
v_mul_f32 v113, s32, v113
v_mfma_f32_16x16x32_bf16 v[156:159], a[224:227], a[20:23], 0
v_mul_f32 v114, s32, v114
s_waitcnt lgkmcnt(6)
v_mfma_f32_16x16x32_bf16 v[136:139], a[228:231], a[24:27], v[136:139]
v_mul_f32 v115, s32, v115
v_mfma_f32_16x16x32_bf16 v[140:143], a[228:231], a[28:31], v[140:143]
v_max3_f32 v24, v24, v112, v113
v_mfma_f32_16x16x32_bf16 v[144:147], a[228:231], a[32:35], v[144:147]
v_xor_b32 v6, 0, v1
s_add_u32 m0, s33, 65536
s_mov_b32 s5, 163840
buffer_load_dwordx4 v6, s[16:19], s5 offen nt lds
v_mfma_f32_16x16x32_bf16 v[148:151], a[228:231], a[36:39], v[148:151]
v_max3_f32 v24, v24, v114, v115
v_mfma_f32_16x16x32_bf16 v[152:155], a[228:231], a[40:43], v[152:155]
v_mul_f32 v116, s32, v116
v_mfma_f32_16x16x32_bf16 v[156:159], a[228:231], a[44:47], v[156:159]
v_mul_f32 v117, s32, v117
s_waitcnt lgkmcnt(5)
v_mfma_f32_16x16x32_bf16 v[136:139], a[232:235], a[48:51], v[136:139]
v_mul_f32 v118, s32, v118
v_mfma_f32_16x16x32_bf16 v[140:143], a[232:235], a[52:55], v[140:143]
v_xor_b32 v2, 32, v1
buffer_load_dwordx4 v2, s[16:19], s5 offen offset:1024 nt lds
v_mfma_f32_16x16x32_bf16 v[144:147], a[232:235], a[56:59], v[144:147]
v_mul_f32 v119, s32, v119
v_mfma_f32_16x16x32_bf16 v[148:151], a[232:235], a[60:63], v[148:151]
v_max3_f32 v25, v25, v116, v117
v_mfma_f32_16x16x32_bf16 v[152:155], a[232:235], a[64:67], v[152:155]
v_max3_f32 v25, v25, v118, v119
v_mfma_f32_16x16x32_bf16 v[156:159], a[232:235], a[68:71], v[156:159]
v_mul_f32 v120, s32, v120
s_waitcnt lgkmcnt(4)
v_mfma_f32_16x16x32_bf16 v[136:139], a[236:239], a[72:75], v[136:139]
v_xor_b32 v6, 64, v1
buffer_load_dwordx4 v6, s[16:19], s5 offen offset:2048 nt lds
v_mfma_f32_16x16x32_bf16 v[140:143], a[236:239], a[76:79], v[140:143]
v_mul_f32 v121, s32, v121
v_mfma_f32_16x16x32_bf16 v[144:147], a[236:239], a[80:83], v[144:147]
v_mul_f32 v122, s32, v122
v_mfma_f32_16x16x32_bf16 v[148:151], a[236:239], a[84:87], v[148:151]
v_mul_f32 v123, s32, v123
v_mfma_f32_16x16x32_bf16 v[152:155], a[236:239], a[88:91], v[152:155]
v_max3_f32 v26, v26, v120, v121
v_mfma_f32_16x16x32_bf16 v[156:159], a[236:239], a[92:95], v[156:159]
v_xor_b32 v2, 96, v1
buffer_load_dwordx4 v2, s[16:19], s5 offen offset:3072 nt lds
s_waitcnt lgkmcnt(3)
v_mfma_f32_16x16x32_bf16 v[136:139], a[240:243], a[96:99], v[136:139]
v_max3_f32 v26, v26, v122, v123
v_mfma_f32_16x16x32_bf16 v[140:143], a[240:243], a[100:103], v[140:143]
v_mul_f32 v124, s32, v124
v_mfma_f32_16x16x32_bf16 v[144:147], a[240:243], a[104:107], v[144:147]
v_mul_f32 v125, s32, v125
v_mfma_f32_16x16x32_bf16 v[148:151], a[240:243], a[108:111], v[148:151]
v_mul_f32 v126, s32, v126
v_mfma_f32_16x16x32_bf16 v[152:155], a[240:243], a[112:115], v[152:155]
v_xor_b32 v6, 128, v1
s_add_u32 m0, s33, 69632
s_mov_b32 s5, 167936
buffer_load_dwordx4 v6, s[16:19], s5 offen nt lds
v_mfma_f32_16x16x32_bf16 v[156:159], a[240:243], a[116:119], v[156:159]
v_mul_f32 v127, s32, v127
s_waitcnt lgkmcnt(2)
v_mfma_f32_16x16x32_bf16 v[136:139], a[244:247], a[120:123], v[136:139]
v_max3_f32 v27, v27, v124, v125
v_mfma_f32_16x16x32_bf16 v[140:143], a[244:247], a[124:127], v[140:143]
v_max3_f32 v27, v27, v126, v127
v_mfma_f32_16x16x32_bf16 v[144:147], a[244:247], a[128:131], v[144:147]
v_mul_f32 v128, s32, v128
v_mfma_f32_16x16x32_bf16 v[148:151], a[244:247], a[132:135], v[148:151]
v_xor_b32 v2, 160, v1
buffer_load_dwordx4 v2, s[16:19], s5 offen offset:1024 nt lds
v_mfma_f32_16x16x32_bf16 v[152:155], a[244:247], a[136:139], v[152:155]
v_mul_f32 v129, s32, v129
v_mfma_f32_16x16x32_bf16 v[156:159], a[244:247], a[140:143], v[156:159]
v_mul_f32 v130, s32, v130
s_waitcnt lgkmcnt(1)
v_mfma_f32_16x16x32_bf16 v[136:139], a[248:251], a[144:147], v[136:139]
v_mul_f32 v131, s32, v131
v_mfma_f32_16x16x32_bf16 v[140:143], a[248:251], a[148:151], v[140:143]
v_max3_f32 v28, v28, v128, v129
v_mfma_f32_16x16x32_bf16 v[144:147], a[248:251], a[152:155], v[144:147]
v_xor_b32 v6, 192, v1
buffer_load_dwordx4 v6, s[16:19], s5 offen offset:2048 nt lds
v_mfma_f32_16x16x32_bf16 v[148:151], a[248:251], a[156:159], v[148:151]
v_max3_f32 v28, v28, v130, v131
v_mfma_f32_16x16x32_bf16 v[152:155], a[248:251], a[160:163], v[152:155]
v_mul_f32 v132, s32, v132
v_mfma_f32_16x16x32_bf16 v[156:159], a[248:251], a[164:167], v[156:159]
v_mul_f32 v133, s32, v133
s_waitcnt lgkmcnt(0)
v_mfma_f32_16x16x32_bf16 v[136:139], a[252:255], a[168:171], v[136:139]
v_mul_f32 v134, s32, v134
v_mfma_f32_16x16x32_bf16 v[140:143], a[252:255], a[172:175], v[140:143]
v_xor_b32 v2, 224, v1
buffer_load_dwordx4 v2, s[16:19], s5 offen offset:3072 nt lds
v_mfma_f32_16x16x32_bf16 v[144:147], a[252:255], a[176:179], v[144:147]
v_mul_f32 v135, s32, v135
v_mfma_f32_16x16x32_bf16 v[148:151], a[252:255], a[180:183], v[148:151]
v_max3_f32 v29, v29, v132, v133
v_mfma_f32_16x16x32_bf16 v[152:155], a[252:255], a[184:187], v[152:155]
v_max3_f32 v29, v29, v134, v135
v_mfma_f32_16x16x32_bf16 v[156:159], a[252:255], a[188:191], v[156:159]
s_add_u32 s4, s33, 4294901760
v_add_u32 v52, s4, v14
v_add_u32 v53, s4, v15
v_add_u32 v54, s4, v16
v_add_u32 v55, s4, v17
s_waitcnt vmcnt(8)
ds_read_b128 a[192:195], v52 offset:0
ds_read_b128 a[196:199], v53 offset:0
ds_read_b128 a[200:203], v54 offset:0
ds_read_b128 a[204:207], v55 offset:0
ds_read_b128 a[208:211], v52 offset:256
ds_read_b128 a[212:215], v53 offset:256
ds_read_b128 a[216:219], v54 offset:256
ds_read_b128 a[220:223], v55 offset:256
s_waitcnt lgkmcnt(7)
v_mfma_f32_16x16x32_bf16 v[160:163], a[192:195], a[0:3], 0
v_mfma_f32_16x16x32_bf16 v[164:167], a[192:195], a[4:7], 0
v_mfma_f32_16x16x32_bf16 v[168:171], a[192:195], a[8:11], 0
v_mul_f32 v136, s32, v136
v_mfma_f32_16x16x32_bf16 v[172:175], a[192:195], a[12:15], 0
v_mfma_f32_16x16x32_bf16 v[176:179], a[192:195], a[16:19], 0
v_mul_f32 v137, s32, v137
v_mfma_f32_16x16x32_bf16 v[180:183], a[192:195], a[20:23], 0
v_mul_f32 v138, s32, v138
s_waitcnt lgkmcnt(6)
v_mfma_f32_16x16x32_bf16 v[160:163], a[196:199], a[24:27], v[160:163]
v_mul_f32 v139, s32, v139
v_mfma_f32_16x16x32_bf16 v[164:167], a[196:199], a[28:31], v[164:167]
v_max3_f32 v24, v24, v136, v137
v_mfma_f32_16x16x32_bf16 v[168:171], a[196:199], a[32:35], v[168:171]
v_xor_b32 v6, 0, v1
s_mov_b32 m0, s33
s_mov_b32 s5, 196608
buffer_load_dwordx4 v6, s[16:19], s5 offen nt lds
v_mfma_f32_16x16x32_bf16 v[172:175], a[196:199], a[36:39], v[172:175]
v_max3_f32 v24, v24, v138, v139
v_mfma_f32_16x16x32_bf16 v[176:179], a[196:199], a[40:43], v[176:179]
v_mul_f32 v140, s32, v140
v_mfma_f32_16x16x32_bf16 v[180:183], a[196:199], a[44:47], v[180:183]
v_mul_f32 v141, s32, v141
s_waitcnt lgkmcnt(5)
v_mfma_f32_16x16x32_bf16 v[160:163], a[200:203], a[48:51], v[160:163]
v_mul_f32 v142, s32, v142
v_mfma_f32_16x16x32_bf16 v[164:167], a[200:203], a[52:55], v[164:167]
v_xor_b32 v2, 32, v1
buffer_load_dwordx4 v2, s[16:19], s5 offen offset:1024 nt lds
v_mfma_f32_16x16x32_bf16 v[168:171], a[200:203], a[56:59], v[168:171]
v_mul_f32 v143, s32, v143
v_mfma_f32_16x16x32_bf16 v[172:175], a[200:203], a[60:63], v[172:175]
v_max3_f32 v25, v25, v140, v141
v_mfma_f32_16x16x32_bf16 v[176:179], a[200:203], a[64:67], v[176:179]
v_max3_f32 v25, v25, v142, v143
v_mfma_f32_16x16x32_bf16 v[180:183], a[200:203], a[68:71], v[180:183]
v_mul_f32 v144, s32, v144
s_waitcnt lgkmcnt(4)
v_mfma_f32_16x16x32_bf16 v[160:163], a[204:207], a[72:75], v[160:163]
v_xor_b32 v6, 64, v1
buffer_load_dwordx4 v6, s[16:19], s5 offen offset:2048 nt lds
v_mfma_f32_16x16x32_bf16 v[164:167], a[204:207], a[76:79], v[164:167]
v_mul_f32 v145, s32, v145
v_mfma_f32_16x16x32_bf16 v[168:171], a[204:207], a[80:83], v[168:171]
v_mul_f32 v146, s32, v146
v_mfma_f32_16x16x32_bf16 v[172:175], a[204:207], a[84:87], v[172:175]
v_mul_f32 v147, s32, v147
v_mfma_f32_16x16x32_bf16 v[176:179], a[204:207], a[88:91], v[176:179]
v_max3_f32 v26, v26, v144, v145
v_mfma_f32_16x16x32_bf16 v[180:183], a[204:207], a[92:95], v[180:183]
v_xor_b32 v2, 96, v1
buffer_load_dwordx4 v2, s[16:19], s5 offen offset:3072 nt lds
s_waitcnt lgkmcnt(3)
v_mfma_f32_16x16x32_bf16 v[160:163], a[208:211], a[96:99], v[160:163]
v_max3_f32 v26, v26, v146, v147
v_mfma_f32_16x16x32_bf16 v[164:167], a[208:211], a[100:103], v[164:167]
v_mul_f32 v148, s32, v148
v_mfma_f32_16x16x32_bf16 v[168:171], a[208:211], a[104:107], v[168:171]
v_mul_f32 v149, s32, v149
v_mfma_f32_16x16x32_bf16 v[172:175], a[208:211], a[108:111], v[172:175]
v_mul_f32 v150, s32, v150
v_mfma_f32_16x16x32_bf16 v[176:179], a[208:211], a[112:115], v[176:179]
v_xor_b32 v6, 128, v1
s_add_u32 m0, s33, 4096
s_mov_b32 s5, 200704
buffer_load_dwordx4 v6, s[16:19], s5 offen nt lds
v_mfma_f32_16x16x32_bf16 v[180:183], a[208:211], a[116:119], v[180:183]
v_mul_f32 v151, s32, v151
s_waitcnt lgkmcnt(2)
v_mfma_f32_16x16x32_bf16 v[160:163], a[212:215], a[120:123], v[160:163]
v_max3_f32 v27, v27, v148, v149
v_mfma_f32_16x16x32_bf16 v[164:167], a[212:215], a[124:127], v[164:167]
v_max3_f32 v27, v27, v150, v151
v_mfma_f32_16x16x32_bf16 v[168:171], a[212:215], a[128:131], v[168:171]
v_mul_f32 v152, s32, v152
v_mfma_f32_16x16x32_bf16 v[172:175], a[212:215], a[132:135], v[172:175]
v_xor_b32 v2, 160, v1
buffer_load_dwordx4 v2, s[16:19], s5 offen offset:1024 nt lds
v_mfma_f32_16x16x32_bf16 v[176:179], a[212:215], a[136:139], v[176:179]
v_mul_f32 v153, s32, v153
v_mfma_f32_16x16x32_bf16 v[180:183], a[212:215], a[140:143], v[180:183]
v_mul_f32 v154, s32, v154
s_waitcnt lgkmcnt(1)
v_mfma_f32_16x16x32_bf16 v[160:163], a[216:219], a[144:147], v[160:163]
v_mul_f32 v155, s32, v155
v_mfma_f32_16x16x32_bf16 v[164:167], a[216:219], a[148:151], v[164:167]
v_max3_f32 v28, v28, v152, v153
v_mfma_f32_16x16x32_bf16 v[168:171], a[216:219], a[152:155], v[168:171]
v_xor_b32 v6, 192, v1
buffer_load_dwordx4 v6, s[16:19], s5 offen offset:2048 nt lds
v_mfma_f32_16x16x32_bf16 v[172:175], a[216:219], a[156:159], v[172:175]
v_max3_f32 v28, v28, v154, v155
v_mfma_f32_16x16x32_bf16 v[176:179], a[216:219], a[160:163], v[176:179]
v_mul_f32 v156, s32, v156
v_mfma_f32_16x16x32_bf16 v[180:183], a[216:219], a[164:167], v[180:183]
v_mul_f32 v157, s32, v157
s_waitcnt lgkmcnt(0)
v_mfma_f32_16x16x32_bf16 v[160:163], a[220:223], a[168:171], v[160:163]
v_mul_f32 v158, s32, v158
v_mfma_f32_16x16x32_bf16 v[164:167], a[220:223], a[172:175], v[164:167]
v_xor_b32 v2, 224, v1
buffer_load_dwordx4 v2, s[16:19], s5 offen offset:3072 nt lds
v_mfma_f32_16x16x32_bf16 v[168:171], a[220:223], a[176:179], v[168:171]
v_mul_f32 v159, s32, v159
v_mfma_f32_16x16x32_bf16 v[172:175], a[220:223], a[180:183], v[172:175]
v_max3_f32 v29, v29, v156, v157
v_mfma_f32_16x16x32_bf16 v[176:179], a[220:223], a[184:187], v[176:179]
v_max3_f32 v29, v29, v158, v159
v_mfma_f32_16x16x32_bf16 v[180:183], a[220:223], a[188:191], v[180:183]
s_add_u32 s4, s33, 4294934528
v_add_u32 v52, s4, v14
v_add_u32 v53, s4, v15
v_add_u32 v54, s4, v16
v_add_u32 v55, s4, v17
s_waitcnt vmcnt(8)
ds_read_b128 a[224:227], v52 offset:0
ds_read_b128 a[228:231], v53 offset:0
ds_read_b128 a[232:235], v54 offset:0
ds_read_b128 a[236:239], v55 offset:0
ds_read_b128 a[240:243], v52 offset:256
ds_read_b128 a[244:247], v53 offset:256
ds_read_b128 a[248:251], v54 offset:256
ds_read_b128 a[252:255], v55 offset:256
s_waitcnt lgkmcnt(7)
v_mfma_f32_16x16x32_bf16 v[184:187], a[224:227], a[0:3], 0
v_mfma_f32_16x16x32_bf16 v[188:191], a[224:227], a[4:7], 0
v_mfma_f32_16x16x32_bf16 v[192:195], a[224:227], a[8:11], 0
v_mul_f32 v160, s32, v160
v_mfma_f32_16x16x32_bf16 v[196:199], a[224:227], a[12:15], 0
v_mfma_f32_16x16x32_bf16 v[200:203], a[224:227], a[16:19], 0
v_mul_f32 v161, s32, v161
v_mfma_f32_16x16x32_bf16 v[204:207], a[224:227], a[20:23], 0
v_mul_f32 v162, s32, v162
s_waitcnt lgkmcnt(6)
v_mfma_f32_16x16x32_bf16 v[184:187], a[228:231], a[24:27], v[184:187]
v_mul_f32 v163, s32, v163
v_mfma_f32_16x16x32_bf16 v[188:191], a[228:231], a[28:31], v[188:191]
v_max3_f32 v24, v24, v160, v161
v_mfma_f32_16x16x32_bf16 v[192:195], a[228:231], a[32:35], v[192:195]
v_xor_b32 v6, 0, v1
s_add_u32 m0, s33, 32768
s_mov_b32 s5, 229376
buffer_load_dwordx4 v6, s[16:19], s5 offen nt lds
v_mfma_f32_16x16x32_bf16 v[196:199], a[228:231], a[36:39], v[196:199]
v_max3_f32 v24, v24, v162, v163
v_mfma_f32_16x16x32_bf16 v[200:203], a[228:231], a[40:43], v[200:203]
v_mul_f32 v164, s32, v164
v_mfma_f32_16x16x32_bf16 v[204:207], a[228:231], a[44:47], v[204:207]
v_mul_f32 v165, s32, v165
s_waitcnt lgkmcnt(5)
v_mfma_f32_16x16x32_bf16 v[184:187], a[232:235], a[48:51], v[184:187]
v_mul_f32 v166, s32, v166
v_mfma_f32_16x16x32_bf16 v[188:191], a[232:235], a[52:55], v[188:191]
v_xor_b32 v2, 32, v1
buffer_load_dwordx4 v2, s[16:19], s5 offen offset:1024 nt lds
v_mfma_f32_16x16x32_bf16 v[192:195], a[232:235], a[56:59], v[192:195]
v_mul_f32 v167, s32, v167
v_mfma_f32_16x16x32_bf16 v[196:199], a[232:235], a[60:63], v[196:199]
v_max3_f32 v25, v25, v164, v165
v_mfma_f32_16x16x32_bf16 v[200:203], a[232:235], a[64:67], v[200:203]
v_max3_f32 v25, v25, v166, v167
v_mfma_f32_16x16x32_bf16 v[204:207], a[232:235], a[68:71], v[204:207]
v_mul_f32 v168, s32, v168
s_waitcnt lgkmcnt(4)
v_mfma_f32_16x16x32_bf16 v[184:187], a[236:239], a[72:75], v[184:187]
v_xor_b32 v6, 64, v1
buffer_load_dwordx4 v6, s[16:19], s5 offen offset:2048 nt lds
v_mfma_f32_16x16x32_bf16 v[188:191], a[236:239], a[76:79], v[188:191]
v_mul_f32 v169, s32, v169
v_mfma_f32_16x16x32_bf16 v[192:195], a[236:239], a[80:83], v[192:195]
v_mul_f32 v170, s32, v170
v_mfma_f32_16x16x32_bf16 v[196:199], a[236:239], a[84:87], v[196:199]
v_mul_f32 v171, s32, v171
v_mfma_f32_16x16x32_bf16 v[200:203], a[236:239], a[88:91], v[200:203]
v_max3_f32 v26, v26, v168, v169
v_mfma_f32_16x16x32_bf16 v[204:207], a[236:239], a[92:95], v[204:207]
v_xor_b32 v2, 96, v1
buffer_load_dwordx4 v2, s[16:19], s5 offen offset:3072 nt lds
s_waitcnt lgkmcnt(3)
v_mfma_f32_16x16x32_bf16 v[184:187], a[240:243], a[96:99], v[184:187]
v_max3_f32 v26, v26, v170, v171
v_mfma_f32_16x16x32_bf16 v[188:191], a[240:243], a[100:103], v[188:191]
v_mul_f32 v172, s32, v172
v_mfma_f32_16x16x32_bf16 v[192:195], a[240:243], a[104:107], v[192:195]
v_mul_f32 v173, s32, v173
v_mfma_f32_16x16x32_bf16 v[196:199], a[240:243], a[108:111], v[196:199]
v_mul_f32 v174, s32, v174
v_mfma_f32_16x16x32_bf16 v[200:203], a[240:243], a[112:115], v[200:203]
v_xor_b32 v6, 128, v1
s_add_u32 m0, s33, 36864
s_mov_b32 s5, 233472
buffer_load_dwordx4 v6, s[16:19], s5 offen nt lds
v_mfma_f32_16x16x32_bf16 v[204:207], a[240:243], a[116:119], v[204:207]
v_mul_f32 v175, s32, v175
s_waitcnt lgkmcnt(2)
v_mfma_f32_16x16x32_bf16 v[184:187], a[244:247], a[120:123], v[184:187]
v_max3_f32 v27, v27, v172, v173
v_mfma_f32_16x16x32_bf16 v[188:191], a[244:247], a[124:127], v[188:191]
v_max3_f32 v27, v27, v174, v175
v_mfma_f32_16x16x32_bf16 v[192:195], a[244:247], a[128:131], v[192:195]
v_mul_f32 v176, s32, v176
v_mfma_f32_16x16x32_bf16 v[196:199], a[244:247], a[132:135], v[196:199]
v_xor_b32 v2, 160, v1
buffer_load_dwordx4 v2, s[16:19], s5 offen offset:1024 nt lds
v_mfma_f32_16x16x32_bf16 v[200:203], a[244:247], a[136:139], v[200:203]
v_mul_f32 v177, s32, v177
v_mfma_f32_16x16x32_bf16 v[204:207], a[244:247], a[140:143], v[204:207]
v_mul_f32 v178, s32, v178
s_waitcnt lgkmcnt(1)
v_mfma_f32_16x16x32_bf16 v[184:187], a[248:251], a[144:147], v[184:187]
v_mul_f32 v179, s32, v179
v_mfma_f32_16x16x32_bf16 v[188:191], a[248:251], a[148:151], v[188:191]
v_max3_f32 v28, v28, v176, v177
v_mfma_f32_16x16x32_bf16 v[192:195], a[248:251], a[152:155], v[192:195]
v_xor_b32 v6, 192, v1
buffer_load_dwordx4 v6, s[16:19], s5 offen offset:2048 nt lds
v_mfma_f32_16x16x32_bf16 v[196:199], a[248:251], a[156:159], v[196:199]
v_max3_f32 v28, v28, v178, v179
v_mfma_f32_16x16x32_bf16 v[200:203], a[248:251], a[160:163], v[200:203]
v_mul_f32 v180, s32, v180
v_mfma_f32_16x16x32_bf16 v[204:207], a[248:251], a[164:167], v[204:207]
v_mul_f32 v181, s32, v181
s_waitcnt lgkmcnt(0)
v_mfma_f32_16x16x32_bf16 v[184:187], a[252:255], a[168:171], v[184:187]
v_mul_f32 v182, s32, v182
v_mfma_f32_16x16x32_bf16 v[188:191], a[252:255], a[172:175], v[188:191]
v_xor_b32 v2, 224, v1
buffer_load_dwordx4 v2, s[16:19], s5 offen offset:3072 nt lds
v_mfma_f32_16x16x32_bf16 v[192:195], a[252:255], a[176:179], v[192:195]
v_mul_f32 v183, s32, v183
v_mfma_f32_16x16x32_bf16 v[196:199], a[252:255], a[180:183], v[196:199]
v_max3_f32 v29, v29, v180, v181
v_mfma_f32_16x16x32_bf16 v[200:203], a[252:255], a[184:187], v[200:203]
v_max3_f32 v29, v29, v182, v183
v_mfma_f32_16x16x32_bf16 v[204:207], a[252:255], a[188:191], v[204:207]
s_add_u32 s4, s33, 4294868992
v_add_u32 v52, s4, v14
v_add_u32 v53, s4, v15
v_add_u32 v54, s4, v16
v_add_u32 v55, s4, v17
s_waitcnt vmcnt(8)
ds_read_b128 a[192:195], v52 offset:0
ds_read_b128 a[196:199], v53 offset:0
ds_read_b128 a[200:203], v54 offset:0
ds_read_b128 a[204:207], v55 offset:0
ds_read_b128 a[208:211], v52 offset:256
ds_read_b128 a[212:215], v53 offset:256
ds_read_b128 a[216:219], v54 offset:256
ds_read_b128 a[220:223], v55 offset:256
s_waitcnt lgkmcnt(7)
v_mfma_f32_16x16x32_bf16 v[208:211], a[192:195], a[0:3], 0
v_mfma_f32_16x16x32_bf16 v[212:215], a[192:195], a[4:7], 0
v_mfma_f32_16x16x32_bf16 v[216:219], a[192:195], a[8:11], 0
v_mul_f32 v184, s32, v184
v_mfma_f32_16x16x32_bf16 v[220:223], a[192:195], a[12:15], 0
v_mfma_f32_16x16x32_bf16 v[224:227], a[192:195], a[16:19], 0
v_mul_f32 v185, s32, v185
v_mfma_f32_16x16x32_bf16 v[228:231], a[192:195], a[20:23], 0
v_mul_f32 v186, s32, v186
s_waitcnt lgkmcnt(6)
v_mfma_f32_16x16x32_bf16 v[208:211], a[196:199], a[24:27], v[208:211]
v_mul_f32 v187, s32, v187
v_mfma_f32_16x16x32_bf16 v[212:215], a[196:199], a[28:31], v[212:215]
v_max3_f32 v24, v24, v184, v185
v_mfma_f32_16x16x32_bf16 v[216:219], a[196:199], a[32:35], v[216:219]
s_add_u32 m0, s33, 65536
s_mov_b32 s5, 0
buffer_load_dwordx4 v3, s[20:23], s5 offen nt lds
v_mfma_f32_16x16x32_bf16 v[220:223], a[196:199], a[36:39], v[220:223]
v_max3_f32 v24, v24, v186, v187
v_mfma_f32_16x16x32_bf16 v[224:227], a[196:199], a[40:43], v[224:227]
v_mul_f32 v188, s32, v188
v_mfma_f32_16x16x32_bf16 v[228:231], a[196:199], a[44:47], v[228:231]
v_mul_f32 v189, s32, v189
s_waitcnt lgkmcnt(5)
v_mfma_f32_16x16x32_bf16 v[208:211], a[200:203], a[48:51], v[208:211]
v_mul_f32 v190, s32, v190
v_mfma_f32_16x16x32_bf16 v[212:215], a[200:203], a[52:55], v[212:215]
buffer_load_dwordx4 v41, s[20:23], s5 offen offset:1024 nt lds
v_mfma_f32_16x16x32_bf16 v[216:219], a[200:203], a[56:59], v[216:219]
v_mul_f32 v191, s32, v191
v_mfma_f32_16x16x32_bf16 v[220:223], a[200:203], a[60:63], v[220:223]
v_max3_f32 v25, v25, v188, v189
v_mfma_f32_16x16x32_bf16 v[224:227], a[200:203], a[64:67], v[224:227]
v_max3_f32 v25, v25, v190, v191
v_mfma_f32_16x16x32_bf16 v[228:231], a[200:203], a[68:71], v[228:231]
v_mul_f32 v192, s32, v192
s_waitcnt lgkmcnt(4)
v_mfma_f32_16x16x32_bf16 v[208:211], a[204:207], a[72:75], v[208:211]
buffer_load_dwordx4 v42, s[20:23], s5 offen offset:2048 nt lds
v_mfma_f32_16x16x32_bf16 v[212:215], a[204:207], a[76:79], v[212:215]
v_mul_f32 v193, s32, v193
v_mfma_f32_16x16x32_bf16 v[216:219], a[204:207], a[80:83], v[216:219]
v_mul_f32 v194, s32, v194
v_mfma_f32_16x16x32_bf16 v[220:223], a[204:207], a[84:87], v[220:223]
v_mul_f32 v195, s32, v195
v_mfma_f32_16x16x32_bf16 v[224:227], a[204:207], a[88:91], v[224:227]
v_max3_f32 v26, v26, v192, v193
v_mfma_f32_16x16x32_bf16 v[228:231], a[204:207], a[92:95], v[228:231]
buffer_load_dwordx4 v43, s[20:23], s5 offen offset:3072 nt lds
s_waitcnt lgkmcnt(3)
v_mfma_f32_16x16x32_bf16 v[208:211], a[208:211], a[96:99], v[208:211]
v_max3_f32 v26, v26, v194, v195
v_mfma_f32_16x16x32_bf16 v[212:215], a[208:211], a[100:103], v[212:215]
v_mul_f32 v196, s32, v196
v_mfma_f32_16x16x32_bf16 v[216:219], a[208:211], a[104:107], v[216:219]
v_mul_f32 v197, s32, v197
v_mfma_f32_16x16x32_bf16 v[220:223], a[208:211], a[108:111], v[220:223]
v_mul_f32 v198, s32, v198
v_mfma_f32_16x16x32_bf16 v[224:227], a[208:211], a[112:115], v[224:227]
s_add_u32 m0, s33, 69632
s_mov_b32 s5, 16384
buffer_load_dwordx4 v3, s[20:23], s5 offen nt lds
v_mfma_f32_16x16x32_bf16 v[228:231], a[208:211], a[116:119], v[228:231]
v_mul_f32 v199, s32, v199
s_waitcnt lgkmcnt(2)
v_mfma_f32_16x16x32_bf16 v[208:211], a[212:215], a[120:123], v[208:211]
v_max3_f32 v27, v27, v196, v197
v_mfma_f32_16x16x32_bf16 v[212:215], a[212:215], a[124:127], v[212:215]
v_max3_f32 v27, v27, v198, v199
v_mfma_f32_16x16x32_bf16 v[216:219], a[212:215], a[128:131], v[216:219]
v_mul_f32 v200, s32, v200
v_mfma_f32_16x16x32_bf16 v[220:223], a[212:215], a[132:135], v[220:223]
buffer_load_dwordx4 v41, s[20:23], s5 offen offset:1024 nt lds
v_mfma_f32_16x16x32_bf16 v[224:227], a[212:215], a[136:139], v[224:227]
v_mul_f32 v201, s32, v201
v_mfma_f32_16x16x32_bf16 v[228:231], a[212:215], a[140:143], v[228:231]
v_mul_f32 v202, s32, v202
s_waitcnt lgkmcnt(1)
v_mfma_f32_16x16x32_bf16 v[208:211], a[216:219], a[144:147], v[208:211]
v_mul_f32 v203, s32, v203
v_mfma_f32_16x16x32_bf16 v[212:215], a[216:219], a[148:151], v[212:215]
v_max3_f32 v28, v28, v200, v201
v_mfma_f32_16x16x32_bf16 v[216:219], a[216:219], a[152:155], v[216:219]
buffer_load_dwordx4 v42, s[20:23], s5 offen offset:2048 nt lds
v_mfma_f32_16x16x32_bf16 v[220:223], a[216:219], a[156:159], v[220:223]
v_max3_f32 v28, v28, v202, v203
v_mfma_f32_16x16x32_bf16 v[224:227], a[216:219], a[160:163], v[224:227]
v_mul_f32 v204, s32, v204
v_mfma_f32_16x16x32_bf16 v[228:231], a[216:219], a[164:167], v[228:231]
v_mul_f32 v205, s32, v205
s_waitcnt lgkmcnt(0)
v_mfma_f32_16x16x32_bf16 v[208:211], a[220:223], a[168:171], v[208:211]
v_mul_f32 v206, s32, v206
v_mfma_f32_16x16x32_bf16 v[212:215], a[220:223], a[172:175], v[212:215]
buffer_load_dwordx4 v43, s[20:23], s5 offen offset:3072 nt lds
v_mfma_f32_16x16x32_bf16 v[216:219], a[220:223], a[176:179], v[216:219]
v_mul_f32 v207, s32, v207
v_mfma_f32_16x16x32_bf16 v[220:223], a[220:223], a[180:183], v[220:223]
v_max3_f32 v29, v29, v204, v205
v_mfma_f32_16x16x32_bf16 v[224:227], a[220:223], a[184:187], v[224:227]
v_max3_f32 v29, v29, v206, v207
v_mfma_f32_16x16x32_bf16 v[228:231], a[220:223], a[188:191], v[228:231]
s_add_u32 s4, s33, 4294901760
v_add_u32 v52, s4, v14
v_add_u32 v53, s4, v15
v_add_u32 v54, s4, v16
v_add_u32 v55, s4, v17
s_waitcnt vmcnt(8)
ds_read_b128 a[224:227], v52 offset:0
ds_read_b128 a[228:231], v53 offset:0
ds_read_b128 a[232:235], v54 offset:0
ds_read_b128 a[236:239], v55 offset:0
ds_read_b128 a[240:243], v52 offset:256
ds_read_b128 a[244:247], v53 offset:256
ds_read_b128 a[248:251], v54 offset:256
ds_read_b128 a[252:255], v55 offset:256
s_waitcnt lgkmcnt(7)
v_mfma_f32_16x16x32_bf16 v[232:235], a[224:227], a[0:3], 0
v_mfma_f32_16x16x32_bf16 v[236:239], a[224:227], a[4:7], 0
v_mfma_f32_16x16x32_bf16 v[240:243], a[224:227], a[8:11], 0
v_mul_f32 v208, s32, v208
v_mfma_f32_16x16x32_bf16 v[244:247], a[224:227], a[12:15], 0
v_mfma_f32_16x16x32_bf16 v[248:251], a[224:227], a[16:19], 0
v_mul_f32 v209, s32, v209
v_mfma_f32_16x16x32_bf16 v[252:255], a[224:227], a[20:23], 0
v_mul_f32 v210, s32, v210
s_waitcnt lgkmcnt(6)
v_mfma_f32_16x16x32_bf16 v[232:235], a[228:231], a[24:27], v[232:235]
v_mul_f32 v211, s32, v211
v_mfma_f32_16x16x32_bf16 v[236:239], a[228:231], a[28:31], v[236:239]
v_max3_f32 v24, v24, v208, v209
v_mfma_f32_16x16x32_bf16 v[240:243], a[228:231], a[32:35], v[240:243]
s_mov_b32 m0, s33
s_mov_b32 s5, 32768
buffer_load_dwordx4 v3, s[20:23], s5 offen nt lds
v_mfma_f32_16x16x32_bf16 v[244:247], a[228:231], a[36:39], v[244:247]
v_max3_f32 v24, v24, v210, v211
v_mfma_f32_16x16x32_bf16 v[248:251], a[228:231], a[40:43], v[248:251]
v_mul_f32 v212, s32, v212
v_mfma_f32_16x16x32_bf16 v[252:255], a[228:231], a[44:47], v[252:255]
v_mul_f32 v213, s32, v213
s_waitcnt lgkmcnt(5)
v_mfma_f32_16x16x32_bf16 v[232:235], a[232:235], a[48:51], v[232:235]
v_mul_f32 v214, s32, v214
v_mfma_f32_16x16x32_bf16 v[236:239], a[232:235], a[52:55], v[236:239]
buffer_load_dwordx4 v41, s[20:23], s5 offen offset:1024 nt lds
v_mfma_f32_16x16x32_bf16 v[240:243], a[232:235], a[56:59], v[240:243]
v_mul_f32 v215, s32, v215
v_mfma_f32_16x16x32_bf16 v[244:247], a[232:235], a[60:63], v[244:247]
v_max3_f32 v25, v25, v212, v213
v_mfma_f32_16x16x32_bf16 v[248:251], a[232:235], a[64:67], v[248:251]
v_max3_f32 v25, v25, v214, v215
v_mfma_f32_16x16x32_bf16 v[252:255], a[232:235], a[68:71], v[252:255]
v_mul_f32 v216, s32, v216
s_waitcnt lgkmcnt(4)
v_mfma_f32_16x16x32_bf16 v[232:235], a[236:239], a[72:75], v[232:235]
buffer_load_dwordx4 v42, s[20:23], s5 offen offset:2048 nt lds
v_mfma_f32_16x16x32_bf16 v[236:239], a[236:239], a[76:79], v[236:239]
v_mul_f32 v217, s32, v217
v_mfma_f32_16x16x32_bf16 v[240:243], a[236:239], a[80:83], v[240:243]
v_mul_f32 v218, s32, v218
v_mfma_f32_16x16x32_bf16 v[244:247], a[236:239], a[84:87], v[244:247]
v_mul_f32 v219, s32, v219
v_mfma_f32_16x16x32_bf16 v[248:251], a[236:239], a[88:91], v[248:251]
v_max3_f32 v26, v26, v216, v217
v_mfma_f32_16x16x32_bf16 v[252:255], a[236:239], a[92:95], v[252:255]
buffer_load_dwordx4 v43, s[20:23], s5 offen offset:3072 nt lds
s_waitcnt lgkmcnt(3)
v_mfma_f32_16x16x32_bf16 v[232:235], a[240:243], a[96:99], v[232:235]
v_max3_f32 v26, v26, v218, v219
v_mfma_f32_16x16x32_bf16 v[236:239], a[240:243], a[100:103], v[236:239]
v_mul_f32 v220, s32, v220
v_mfma_f32_16x16x32_bf16 v[240:243], a[240:243], a[104:107], v[240:243]
v_mul_f32 v221, s32, v221
v_mfma_f32_16x16x32_bf16 v[244:247], a[240:243], a[108:111], v[244:247]
v_mul_f32 v222, s32, v222
v_mfma_f32_16x16x32_bf16 v[248:251], a[240:243], a[112:115], v[248:251]
s_add_u32 m0, s33, 4096
s_mov_b32 s5, 49152
buffer_load_dwordx4 v3, s[20:23], s5 offen nt lds
v_mfma_f32_16x16x32_bf16 v[252:255], a[240:243], a[116:119], v[252:255]
v_mul_f32 v223, s32, v223
s_waitcnt lgkmcnt(2)
v_mfma_f32_16x16x32_bf16 v[232:235], a[244:247], a[120:123], v[232:235]
v_max3_f32 v27, v27, v220, v221
v_mfma_f32_16x16x32_bf16 v[236:239], a[244:247], a[124:127], v[236:239]
v_max3_f32 v27, v27, v222, v223
v_mfma_f32_16x16x32_bf16 v[240:243], a[244:247], a[128:131], v[240:243]
v_mul_f32 v224, s32, v224
v_mfma_f32_16x16x32_bf16 v[244:247], a[244:247], a[132:135], v[244:247]
buffer_load_dwordx4 v41, s[20:23], s5 offen offset:1024 nt lds
v_mfma_f32_16x16x32_bf16 v[248:251], a[244:247], a[136:139], v[248:251]
v_mul_f32 v225, s32, v225
v_mfma_f32_16x16x32_bf16 v[252:255], a[244:247], a[140:143], v[252:255]
v_mul_f32 v226, s32, v226
s_waitcnt lgkmcnt(1)
v_mfma_f32_16x16x32_bf16 v[232:235], a[248:251], a[144:147], v[232:235]
v_mul_f32 v227, s32, v227
v_mfma_f32_16x16x32_bf16 v[236:239], a[248:251], a[148:151], v[236:239]
v_max3_f32 v28, v28, v224, v225
v_mfma_f32_16x16x32_bf16 v[240:243], a[248:251], a[152:155], v[240:243]
buffer_load_dwordx4 v42, s[20:23], s5 offen offset:2048 nt lds
v_mfma_f32_16x16x32_bf16 v[244:247], a[248:251], a[156:159], v[244:247]
v_max3_f32 v28, v28, v226, v227
v_mfma_f32_16x16x32_bf16 v[248:251], a[248:251], a[160:163], v[248:251]
v_mul_f32 v228, s32, v228
v_mfma_f32_16x16x32_bf16 v[252:255], a[248:251], a[164:167], v[252:255]
v_mul_f32 v229, s32, v229
s_waitcnt lgkmcnt(0)
v_mfma_f32_16x16x32_bf16 v[232:235], a[252:255], a[168:171], v[232:235]
v_mul_f32 v230, s32, v230
v_mfma_f32_16x16x32_bf16 v[236:239], a[252:255], a[172:175], v[236:239]
buffer_load_dwordx4 v43, s[20:23], s5 offen offset:3072 nt lds
v_mfma_f32_16x16x32_bf16 v[240:243], a[252:255], a[176:179], v[240:243]
v_mul_f32 v231, s32, v231
v_mfma_f32_16x16x32_bf16 v[244:247], a[252:255], a[180:183], v[244:247]
v_max3_f32 v29, v29, v228, v229
v_mfma_f32_16x16x32_bf16 v[248:251], a[252:255], a[184:187], v[248:251]
v_max3_f32 v29, v29, v230, v231
v_mfma_f32_16x16x32_bf16 v[252:255], a[252:255], a[188:191], v[252:255]
v_add_u32 v38, 0x10000, v8
v_add_u32 v39, 0x10000, v9
v_add_u32 v6, 122880, v8
v_add_u32 v7, 122880, v9
v_mul_f32 v232, s32, v232
v_mul_f32 v233, s32, v233
v_mul_f32 v234, s32, v234
v_mul_f32 v235, s32, v235
v_max3_f32 v24, v24, v232, v233
v_max3_f32 v24, v24, v234, v235
v_mul_f32 v236, s32, v236
v_mul_f32 v237, s32, v237
v_mul_f32 v238, s32, v238
v_mul_f32 v239, s32, v239
v_max3_f32 v25, v25, v236, v237
v_max3_f32 v25, v25, v238, v239
v_mul_f32 v240, s32, v240
v_mul_f32 v241, s32, v241
v_mul_f32 v242, s32, v242
v_mul_f32 v243, s32, v243
v_max3_f32 v26, v26, v240, v241
v_max3_f32 v26, v26, v242, v243
v_mul_f32 v244, s32, v244
v_mul_f32 v245, s32, v245
v_mul_f32 v246, s32, v246
v_mul_f32 v247, s32, v247
v_max3_f32 v27, v27, v244, v245
v_max3_f32 v27, v27, v246, v247
v_mul_f32 v248, s32, v248
v_mul_f32 v249, s32, v249
v_mul_f32 v250, s32, v250
v_mul_f32 v251, s32, v251
v_max3_f32 v28, v28, v248, v249
v_max3_f32 v28, v28, v250, v251
v_mul_f32 v252, s32, v252
v_mul_f32 v253, s32, v253
v_mul_f32 v254, s32, v254
v_mul_f32 v255, s32, v255
v_max3_f32 v29, v29, v252, v253
v_max3_f32 v29, v29, v254, v255
v_mov_b32 v44, v24
v_mov_b32 v45, v25
v_mov_b32 v46, v26
v_mov_b32 v47, v27
v_mov_b32 v48, v28
v_mov_b32 v49, v29
v_permlane32_swap_b32 v44, v24
v_permlane32_swap_b32 v45, v25
v_permlane32_swap_b32 v46, v26
v_permlane32_swap_b32 v47, v27
v_permlane32_swap_b32 v48, v28
v_permlane32_swap_b32 v49, v29
v_max_f32 v24, v24, v44
v_max_f32 v25, v25, v45
v_max_f32 v26, v26, v46
v_max_f32 v27, v27, v47
v_max_f32 v28, v28, v48
v_max_f32 v29, v29, v49
v_mov_b32 v44, v24
v_mov_b32 v45, v25
v_mov_b32 v46, v26
v_mov_b32 v47, v27
v_mov_b32 v48, v28
v_mov_b32 v49, v29
v_permlane16_swap_b32 v44, v24
v_permlane16_swap_b32 v45, v25
v_permlane16_swap_b32 v46, v26
v_permlane16_swap_b32 v47, v27
v_permlane16_swap_b32 v48, v28
v_permlane16_swap_b32 v49, v29
v_max_f32 v24, v24, v44
v_max_f32 v25, v25, v45
v_max_f32 v26, v26, v46
v_max_f32 v27, v27, v47
v_max_f32 v28, v28, v48
v_max_f32 v29, v29, v49
ds_write_b32 v21, v24 offset:0
ds_write_b32 v21, v25 offset:256
ds_write_b32 v21, v26 offset:512
ds_write_b32 v21, v27 offset:768
ds_write_b32 v21, v28 offset:1024
ds_write_b32 v21, v29 offset:1280
s_waitcnt lgkmcnt(0)
s_barrier
ds_read_b128 v[44:47], v22 offset:0
ds_read_b128 v[48:51], v22 offset:256
ds_read_b128 v[52:55], v22 offset:512
ds_read_b128 v[56:59], v22 offset:768
ds_read_b128 v[60:63], v22 offset:1024
s_waitcnt lgkmcnt(4)
v_max3_f32 v24, v44, v45, v46
v_max_f32 v24, v24, v47
s_waitcnt lgkmcnt(3)
v_max3_f32 v25, v48, v49, v50
v_max_f32 v25, v25, v51
s_waitcnt lgkmcnt(2)
v_max3_f32 v26, v52, v53, v54
v_max_f32 v26, v26, v55
s_waitcnt lgkmcnt(1)
v_max3_f32 v27, v56, v57, v58
v_max_f32 v27, v27, v59
s_waitcnt lgkmcnt(0)
v_max3_f32 v28, v60, v61, v62
v_max_f32 v28, v28, v63
ds_read_b128 v[44:47], v22 offset:1280
s_waitcnt lgkmcnt(0)
v_max3_f32 v29, v44, v45, v46
v_max_f32 v29, v29, v47
v_add_u32 v10, 4294950912, v10
v_add_u32 v11, 4294950912, v11
v_add_u32 v12, 4294950912, v12
v_add_u32 v13, 4294950912, v13
s_mov_b32 s95, 0x3f803f80
v_mov_b32 v30, 0
v_mov_b32 v31, 0
v_mov_b32 v32, 0
v_mov_b32 v33, 0
v_mov_b32 v34, 0
v_mov_b32 v35, 0
v_sub_f32 v44, v64, v24
v_sub_f32 v45, v65, v24
v_sub_f32 v46, v66, v24
v_sub_f32 v47, v67, v24
v_exp_f32 v44, v44
v_exp_f32 v45, v45
v_exp_f32 v46, v46
v_exp_f32 v47, v47
v_add_f32 v30, v30, v44
v_cvt_pk_bf16_f32 v56, v44, v45
v_add_f32 v30, v30, v45
s_add_u32 m0, s33, 32768
s_mov_b32 s5, 65536
buffer_load_dwordx4 v3, s[20:23], s5 offen nt lds
v_cvt_pk_bf16_f32 v57, v46, v47
v_add_f32 v30, v30, v46
v_add_f32 v30, v30, v47
ds_write_b64 v18, v[56:57] offset:0
v_sub_f32 v48, v68, v25
v_sub_f32 v49, v69, v25
v_sub_f32 v50, v70, v25
v_sub_f32 v51, v71, v25
v_exp_f32 v48, v48
v_exp_f32 v49, v49
buffer_load_dwordx4 v41, s[20:23], s5 offen offset:1024 nt lds
v_exp_f32 v50, v50
v_exp_f32 v51, v51
v_add_f32 v31, v31, v48
v_cvt_pk_bf16_f32 v58, v48, v49
v_add_f32 v31, v31, v49
v_cvt_pk_bf16_f32 v59, v50, v51
v_add_f32 v31, v31, v50
v_add_f32 v31, v31, v51
ds_write_b64 v18, v[58:59] offset:2048
v_sub_f32 v44, v72, v26
buffer_load_dwordx4 v42, s[20:23], s5 offen offset:2048 nt lds
v_sub_f32 v45, v73, v26
v_sub_f32 v46, v74, v26
v_sub_f32 v47, v75, v26
v_exp_f32 v44, v44
v_exp_f32 v45, v45
v_exp_f32 v46, v46
v_exp_f32 v47, v47
v_add_f32 v32, v32, v44
v_cvt_pk_bf16_f32 v56, v44, v45
v_add_f32 v32, v32, v45
buffer_load_dwordx4 v43, s[20:23], s5 offen offset:3072 nt lds
v_cvt_pk_bf16_f32 v57, v46, v47
v_add_f32 v32, v32, v46
v_add_f32 v32, v32, v47
ds_write_b64 v18, v[56:57] offset:4096
v_sub_f32 v48, v76, v27
v_sub_f32 v49, v77, v27
v_sub_f32 v50, v78, v27
v_sub_f32 v51, v79, v27
v_exp_f32 v48, v48
v_exp_f32 v49, v49
s_add_u32 m0, s33, 36864
s_mov_b32 s5, 81920
buffer_load_dwordx4 v3, s[20:23], s5 offen nt lds
v_exp_f32 v50, v50
v_exp_f32 v51, v51
v_add_f32 v33, v33, v48
v_cvt_pk_bf16_f32 v58, v48, v49
v_add_f32 v33, v33, v49
v_cvt_pk_bf16_f32 v59, v50, v51
v_add_f32 v33, v33, v50
v_add_f32 v33, v33, v51
ds_write_b64 v18, v[58:59] offset:6144
v_sub_f32 v44, v80, v28
buffer_load_dwordx4 v41, s[20:23], s5 offen offset:1024 nt lds
v_sub_f32 v45, v81, v28
v_sub_f32 v46, v82, v28
v_sub_f32 v47, v83, v28
v_exp_f32 v44, v44
v_exp_f32 v45, v45
v_exp_f32 v46, v46
v_exp_f32 v47, v47
v_add_f32 v34, v34, v44
v_cvt_pk_bf16_f32 v56, v44, v45
v_add_f32 v34, v34, v45
buffer_load_dwordx4 v42, s[20:23], s5 offen offset:2048 nt lds
v_cvt_pk_bf16_f32 v57, v46, v47
v_add_f32 v34, v34, v46
v_add_f32 v34, v34, v47
ds_write_b64 v18, v[56:57] offset:8192
v_sub_f32 v48, v84, v29
v_sub_f32 v49, v85, v29
v_sub_f32 v50, v86, v29
v_sub_f32 v51, v87, v29
v_exp_f32 v48, v48
v_exp_f32 v49, v49
buffer_load_dwordx4 v43, s[20:23], s5 offen offset:3072 nt lds
v_exp_f32 v50, v50
v_exp_f32 v51, v51
v_add_f32 v35, v35, v48
v_cvt_pk_bf16_f32 v58, v48, v49
v_add_f32 v35, v35, v49
v_cvt_pk_bf16_f32 v59, v50, v51
v_add_f32 v35, v35, v50
v_add_f32 v35, v35, v51
ds_write_b64 v18, v[58:59] offset:10240
s_cmp_eq_u32 s79, 7
s_cselect_b32 s71, 0, s79
s_mov_b32 s4, s71
s_lshl_b32 s36, s4, 7
s_lshl_b32 s6, s4, 2
s_add_u32 s6, s6, s3
s_mul_i32 s44, s6, 3072
s_add_u32 s4, s4, 1
s_cmp_eq_u32 s4, 7
s_cselect_b32 s4, 0, s4
s_lshl_b32 s37, s4, 7
s_lshl_b32 s6, s4, 2
s_add_u32 s6, s6, s3
s_mul_i32 s45, s6, 3072
s_add_u32 s4, s4, 1
s_cmp_eq_u32 s4, 7
s_cselect_b32 s4, 0, s4
s_lshl_b32 s38, s4, 7
s_lshl_b32 s6, s4, 2
s_add_u32 s6, s6, s3
s_mul_i32 s46, s6, 3072
s_add_u32 s4, s4, 1
s_cmp_eq_u32 s4, 7
s_cselect_b32 s4, 0, s4
s_lshl_b32 s39, s4, 7
s_lshl_b32 s6, s4, 2
s_add_u32 s6, s6, s3
s_mul_i32 s47, s6, 3072
s_add_u32 s4, s4, 1
s_cmp_eq_u32 s4, 7
s_cselect_b32 s4, 0, s4
s_lshl_b32 s40, s4, 7
s_lshl_b32 s6, s4, 2
s_add_u32 s6, s6, s3
s_mul_i32 s48, s6, 3072
s_add_u32 s4, s4, 1
s_cmp_eq_u32 s4, 7
s_cselect_b32 s4, 0, s4
s_lshl_b32 s41, s4, 7
s_lshl_b32 s6, s4, 2
s_add_u32 s6, s6, s3
s_mul_i32 s49, s6, 3072
s_add_u32 s4, s4, 1
s_cmp_eq_u32 s4, 7
s_cselect_b32 s4, 0, s4
s_lshl_b32 s42, s4, 7
s_lshl_b32 s6, s4, 2
s_add_u32 s6, s6, s3
s_mul_i32 s50, s6, 3072
s_waitcnt lgkmcnt(0)
s_barrier
s_waitcnt vmcnt(16)
ds_read_b64_tr_b16 a[96:97], v38 offset:0
ds_read_b64_tr_b16 a[98:99], v38 offset:512
ds_read_b128 a[104:107], v10 offset:0
ds_read_b64_tr_b16 a[100:101], v39 offset:0
ds_read_b64_tr_b16 a[102:103], v39 offset:512
ds_read_b128 a[108:111], v10 offset:4096
ds_read_b128 a[112:115], v10 offset:8192
s_waitcnt lgkmcnt(4)
v_mfma_f32_32x32x16_bf16 a[0:15], a[96:99], a[104:107], 0
v_sub_f32 v44, v88, v24
v_sub_f32 v45, v89, v24
v_sub_f32 v46, v90, v24
ds_read_b64_tr_b16 a[116:117], v38 offset:2048
v_sub_f32 v47, v91, v24
v_exp_f32 v44, v44
ds_read_b64_tr_b16 a[118:119], v38 offset:2560
v_exp_f32 v45, v45
v_exp_f32 v46, v46
v_exp_f32 v47, v47
s_waitcnt lgkmcnt(4)
v_mfma_f32_32x32x16_bf16 a[48:63], a[100:103], a[104:107], 0
v_add_f32 v30, v30, v44
v_cvt_pk_bf16_f32 v56, v44, v45
ds_read_b128 a[124:127], v11 offset:0
v_add_f32 v30, v30, v45
v_cvt_pk_bf16_f32 v57, v46, v47
ds_read_b64_tr_b16 a[120:121], v39 offset:2048
v_add_f32 v30, v30, v46
v_add_f32 v30, v30, v47
ds_write_b64 v18, v[56:57] offset:12288
s_waitcnt lgkmcnt(6)
v_mfma_f32_32x32x16_bf16 a[16:31], a[96:99], a[108:111], 0
v_sub_f32 v48, v92, v25
v_sub_f32 v49, v93, v25
ds_read_b64_tr_b16 a[122:123], v39 offset:2560
v_sub_f32 v50, v94, v25
v_sub_f32 v51, v95, v25
ds_read_b128 a[128:131], v11 offset:4096
v_exp_f32 v48, v48
v_exp_f32 v49, v49
v_exp_f32 v50, v50
v_mfma_f32_32x32x16_bf16 a[64:79], a[100:103], a[108:111], 0
v_exp_f32 v51, v51
v_add_f32 v31, v31, v48
ds_read_b128 a[132:135], v11 offset:8192
v_cvt_pk_bf16_f32 v58, v48, v49
v_add_f32 v31, v31, v49
v_cvt_pk_bf16_f32 v59, v50, v51
s_waitcnt lgkmcnt(8)
v_mfma_f32_32x32x16_bf16 a[32:47], a[96:99], a[112:115], 0
v_add_f32 v31, v31, v50
v_add_f32 v31, v31, v51
v_mfma_f32_32x32x16_bf16 a[80:95], a[100:103], a[112:115], 0
ds_write_b64 v18, v[58:59] offset:14336
v_sub_f32 v44, v96, v26
s_waitcnt lgkmcnt(6)
v_mfma_f32_32x32x16_bf16 a[0:15], a[116:119], a[124:127], a[0:15]
v_sub_f32 v45, v97, v26
v_sub_f32 v46, v98, v26
v_sub_f32 v47, v99, v26
ds_read_b64_tr_b16 a[96:97], v38 offset:4096
v_exp_f32 v44, v44
v_exp_f32 v45, v45
ds_read_b64_tr_b16 a[98:99], v38 offset:4608
v_exp_f32 v46, v46
v_exp_f32 v47, v47
s_waitcnt lgkmcnt(5)
v_mfma_f32_32x32x16_bf16 a[48:63], a[120:123], a[124:127], a[48:63]
v_add_f32 v32, v32, v44
v_cvt_pk_bf16_f32 v56, v44, v45
v_add_f32 v32, v32, v45
ds_read_b128 a[104:107], v12 offset:0
v_cvt_pk_bf16_f32 v57, v46, v47
v_add_f32 v32, v32, v46
ds_read_b64_tr_b16 a[100:101], v39 offset:4096
v_add_f32 v32, v32, v47
ds_write_b64 v18, v[56:57] offset:16384
s_waitcnt lgkmcnt(7)
v_mfma_f32_32x32x16_bf16 a[16:31], a[116:119], a[128:131], a[16:31]
v_sub_f32 v48, v100, v27
v_sub_f32 v49, v101, v27
v_sub_f32 v50, v102, v27
ds_read_b64_tr_b16 a[102:103], v39 offset:4608
v_sub_f32 v51, v103, v27
v_exp_f32 v48, v48
ds_read_b128 a[108:111], v12 offset:4096
v_exp_f32 v49, v49
v_exp_f32 v50, v50
v_exp_f32 v51, v51
v_mfma_f32_32x32x16_bf16 a[64:79], a[120:123], a[128:131], a[64:79]
v_add_f32 v33, v33, v48
v_cvt_pk_bf16_f32 v58, v48, v49
ds_read_b128 a[112:115], v12 offset:8192
v_add_f32 v33, v33, v49
v_cvt_pk_bf16_f32 v59, v50, v51
s_waitcnt lgkmcnt(9)
v_mfma_f32_32x32x16_bf16 a[32:47], a[116:119], a[132:135], a[32:47]
v_add_f32 v33, v33, v50
v_add_f32 v33, v33, v51
ds_write_b64 v18, v[58:59] offset:18432
v_mfma_f32_32x32x16_bf16 a[80:95], a[120:123], a[132:135], a[80:95]
v_sub_f32 v44, v104, v28
v_sub_f32 v45, v105, v28
s_waitcnt lgkmcnt(6)
v_mfma_f32_32x32x16_bf16 a[0:15], a[96:99], a[104:107], a[0:15]
v_sub_f32 v46, v106, v28
v_sub_f32 v47, v107, v28
ds_read_b64_tr_b16 a[116:117], v38 offset:6144
v_exp_f32 v44, v44
v_exp_f32 v45, v45
v_exp_f32 v46, v46
ds_read_b64_tr_b16 a[118:119], v38 offset:6656
v_exp_f32 v47, v47
v_add_f32 v34, v34, v44
s_waitcnt lgkmcnt(5)
v_mfma_f32_32x32x16_bf16 a[48:63], a[100:103], a[104:107], a[48:63]
v_cvt_pk_bf16_f32 v56, v44, v45
v_add_f32 v34, v34, v45
v_cvt_pk_bf16_f32 v57, v46, v47
ds_read_b128 a[124:127], v13 offset:0
v_add_f32 v34, v34, v46
v_add_f32 v34, v34, v47
ds_read_b64_tr_b16 a[120:121], v39 offset:6144
ds_write_b64 v18, v[56:57] offset:20480
v_sub_f32 v48, v108, v29
s_waitcnt lgkmcnt(7)
v_mfma_f32_32x32x16_bf16 a[16:31], a[96:99], a[108:111], a[16:31]
v_sub_f32 v49, v109, v29
v_sub_f32 v50, v110, v29
v_sub_f32 v51, v111, v29
ds_read_b64_tr_b16 a[122:123], v39 offset:6656
v_exp_f32 v48, v48
v_exp_f32 v49, v49
ds_read_b128 a[128:131], v13 offset:4096
v_exp_f32 v50, v50
v_exp_f32 v51, v51
v_mfma_f32_32x32x16_bf16 a[64:79], a[100:103], a[108:111], a[64:79]
v_add_f32 v35, v35, v48
v_cvt_pk_bf16_f32 v58, v48, v49
v_add_f32 v35, v35, v49
ds_read_b128 a[132:135], v13 offset:8192
v_cvt_pk_bf16_f32 v59, v50, v51
v_add_f32 v35, v35, v50
s_waitcnt lgkmcnt(9)
v_mfma_f32_32x32x16_bf16 a[32:47], a[96:99], a[112:115], a[32:47]
v_add_f32 v35, v35, v51
ds_write_b64 v18, v[58:59] offset:22528
v_mfma_f32_32x32x16_bf16 a[80:95], a[100:103], a[112:115], a[80:95]
s_waitcnt lgkmcnt(0)
s_barrier
v_mfma_f32_32x32x16_bf16 a[0:15], a[116:119], a[124:127], a[0:15]
ds_read_b128 a[104:107], v10 offset:12288
ds_read_b128 a[108:111], v10 offset:16384
ds_read_b128 a[112:115], v10 offset:20480
v_mfma_f32_32x32x16_bf16 a[48:63], a[120:123], a[124:127], a[48:63]
s_waitcnt vmcnt(8)
ds_read_b64_tr_b16 a[96:97], v8 offset:0
ds_read_b64_tr_b16 a[98:99], v8 offset:512
ds_read_b64_tr_b16 a[100:101], v9 offset:0
ds_read_b64_tr_b16 a[102:103], v9 offset:512
v_mfma_f32_32x32x16_bf16 a[16:31], a[116:119], a[128:131], a[16:31]
v_mfma_f32_32x32x16_bf16 a[64:79], a[120:123], a[128:131], a[64:79]
v_mfma_f32_32x32x16_bf16 a[32:47], a[116:119], a[132:135], a[32:47]
v_mfma_f32_32x32x16_bf16 a[80:95], a[120:123], a[132:135], a[80:95]
s_waitcnt lgkmcnt(2)
v_mfma_f32_32x32x16_bf16 a[0:15], a[96:99], a[104:107], a[0:15]
v_sub_f32 v44, v112, v24
v_mov_b32 v63, 0
global_load_dword v40, v63, s[96:97] sc1
v_sub_f32 v45, v113, v24
ds_read_b64_tr_b16 a[116:117], v8 offset:2048
v_sub_f32 v46, v114, v24
v_sub_f32 v47, v115, v24
v_exp_f32 v44, v44
ds_read_b64_tr_b16 a[118:119], v8 offset:2560
v_exp_f32 v45, v45
v_exp_f32 v46, v46
s_waitcnt lgkmcnt(2)
v_mfma_f32_32x32x16_bf16 a[48:63], a[100:103], a[104:107], a[48:63]
v_exp_f32 v47, v47
v_add_f32 v30, v30, v44
v_cvt_pk_bf16_f32 v56, v44, v45
ds_read_b128 a[124:127], v11 offset:12288
v_add_f32 v30, v30, v45
v_cvt_pk_bf16_f32 v57, v46, v47
ds_read_b64_tr_b16 a[120:121], v9 offset:2048
v_add_f32 v30, v30, v46
v_add_f32 v30, v30, v47
v_mfma_f32_32x32x16_bf16 a[16:31], a[96:99], a[108:111], a[16:31]
ds_write_b64 v18, v[56:57] offset:0
v_sub_f32 v48, v116, v25
v_sub_f32 v49, v117, v25
ds_read_b64_tr_b16 a[122:123], v9 offset:2560
v_sub_f32 v50, v118, v25
v_sub_f32 v51, v119, v25
s_add_u32 m0, s33, 65536
s_mov_b32 s5, 98304
buffer_load_dwordx4 v3, s[20:23], s5 offen nt lds
ds_read_b128 a[128:131], v11 offset:16384
v_exp_f32 v48, v48
v_exp_f32 v49, v49
v_mfma_f32_32x32x16_bf16 a[64:79], a[100:103], a[108:111], a[64:79]
v_exp_f32 v50, v50
v_exp_f32 v51, v51
v_add_f32 v31, v31, v48
ds_read_b128 a[132:135], v11 offset:20480
v_cvt_pk_bf16_f32 v58, v48, v49
v_add_f32 v31, v31, v49
v_mfma_f32_32x32x16_bf16 a[32:47], a[96:99], a[112:115], a[32:47]
v_cvt_pk_bf16_f32 v59, v50, v51
v_add_f32 v31, v31, v50
buffer_load_dwordx4 v41, s[20:23], s5 offen offset:1024 nt lds
v_mfma_f32_32x32x16_bf16 a[80:95], a[100:103], a[112:115], a[80:95]
v_add_f32 v31, v31, v51
ds_write_b64 v18, v[58:59] offset:2048
v_sub_f32 v44, v120, v26
s_waitcnt lgkmcnt(6)
v_mfma_f32_32x32x16_bf16 a[0:15], a[116:119], a[124:127], a[0:15]
v_sub_f32 v45, v121, v26
v_sub_f32 v46, v122, v26
ds_read_b64_tr_b16 a[96:97], v8 offset:4096
v_sub_f32 v47, v123, v26
v_exp_f32 v44, v44
v_exp_f32 v45, v45
ds_read_b64_tr_b16 a[98:99], v8 offset:4608
v_exp_f32 v46, v46
buffer_load_dwordx4 v42, s[20:23], s5 offen offset:2048 nt lds
v_exp_f32 v47, v47
s_waitcnt lgkmcnt(5)
v_mfma_f32_32x32x16_bf16 a[48:63], a[120:123], a[124:127], a[48:63]
v_add_f32 v32, v32, v44
v_cvt_pk_bf16_f32 v56, v44, v45
ds_read_b128 a[104:107], v12 offset:12288
v_add_f32 v32, v32, v45
v_cvt_pk_bf16_f32 v57, v46, v47
v_add_f32 v32, v32, v46
ds_read_b64_tr_b16 a[100:101], v9 offset:4096
v_add_f32 v32, v32, v47
ds_write_b64 v18, v[56:57] offset:4096
s_waitcnt lgkmcnt(7)
v_mfma_f32_32x32x16_bf16 a[16:31], a[116:119], a[128:131], a[16:31]
v_sub_f32 v48, v124, v27
buffer_load_dwordx4 v43, s[20:23], s5 offen offset:3072 nt lds
v_sub_f32 v49, v125, v27
ds_read_b64_tr_b16 a[102:103], v9 offset:4608
v_sub_f32 v50, v126, v27
v_sub_f32 v51, v127, v27
v_exp_f32 v48, v48
ds_read_b128 a[108:111], v12 offset:16384
v_exp_f32 v49, v49
v_exp_f32 v50, v50
v_mfma_f32_32x32x16_bf16 a[64:79], a[120:123], a[128:131], a[64:79]
v_exp_f32 v51, v51
v_add_f32 v33, v33, v48
v_cvt_pk_bf16_f32 v58, v48, v49
ds_read_b128 a[112:115], v12 offset:20480
s_add_u32 m0, s33, 69632
s_mov_b32 s5, 114688
buffer_load_dwordx4 v3, s[20:23], s5 offen nt lds
v_add_f32 v33, v33, v49
v_cvt_pk_bf16_f32 v59, v50, v51
s_waitcnt lgkmcnt(9)
v_mfma_f32_32x32x16_bf16 a[32:47], a[116:119], a[132:135], a[32:47]
v_add_f32 v33, v33, v50
v_add_f32 v33, v33, v51
v_mfma_f32_32x32x16_bf16 a[80:95], a[120:123], a[132:135], a[80:95]
ds_write_b64 v18, v[58:59] offset:6144
v_sub_f32 v44, v128, v28
v_sub_f32 v45, v129, v28
s_waitcnt lgkmcnt(6)
v_mfma_f32_32x32x16_bf16 a[0:15], a[96:99], a[104:107], a[0:15]
v_sub_f32 v46, v130, v28
v_sub_f32 v47, v131, v28
buffer_load_dwordx4 v41, s[20:23], s5 offen offset:1024 nt lds
ds_read_b64_tr_b16 a[116:117], v8 offset:6144
v_exp_f32 v44, v44
v_exp_f32 v45, v45
ds_read_b64_tr_b16 a[118:119], v8 offset:6656
v_exp_f32 v46, v46
v_exp_f32 v47, v47
v_add_f32 v34, v34, v44
s_waitcnt lgkmcnt(5)
v_mfma_f32_32x32x16_bf16 a[48:63], a[100:103], a[104:107], a[48:63]
v_cvt_pk_bf16_f32 v56, v44, v45
v_add_f32 v34, v34, v45
ds_read_b128 a[124:127], v13 offset:12288
v_cvt_pk_bf16_f32 v57, v46, v47
v_add_f32 v34, v34, v46
buffer_load_dwordx4 v42, s[20:23], s5 offen offset:2048 nt lds
ds_read_b64_tr_b16 a[120:121], v9 offset:6144
v_add_f32 v34, v34, v47
ds_write_b64 v18, v[56:57] offset:8192
v_sub_f32 v48, v132, v29
s_waitcnt lgkmcnt(7)
v_mfma_f32_32x32x16_bf16 a[16:31], a[96:99], a[108:111], a[16:31]
v_sub_f32 v49, v133, v29
v_sub_f32 v50, v134, v29
ds_read_b64_tr_b16 a[122:123], v9 offset:6656
v_sub_f32 v51, v135, v29
v_exp_f32 v48, v48
v_exp_f32 v49, v49
ds_read_b128 a[128:131], v13 offset:16384
v_exp_f32 v50, v50
buffer_load_dwordx4 v43, s[20:23], s5 offen offset:3072 nt lds
v_exp_f32 v51, v51
v_mfma_f32_32x32x16_bf16 a[64:79], a[100:103], a[108:111], a[64:79]
v_add_f32 v35, v35, v48
v_cvt_pk_bf16_f32 v58, v48, v49
ds_read_b128 a[132:135], v13 offset:20480
v_add_f32 v35, v35, v49
v_cvt_pk_bf16_f32 v59, v50, v51
v_add_f32 v35, v35, v50
s_waitcnt lgkmcnt(9)
v_mfma_f32_32x32x16_bf16 a[32:47], a[96:99], a[112:115], a[32:47]
v_add_f32 v35, v35, v51
ds_write_b64 v18, v[58:59] offset:10240
v_mfma_f32_32x32x16_bf16 a[80:95], a[100:103], a[112:115], a[80:95]
s_waitcnt lgkmcnt(0)
s_barrier
v_mfma_f32_32x32x16_bf16 a[0:15], a[116:119], a[124:127], a[0:15]
ds_read_b128 a[104:107], v10 offset:0
ds_read_b128 a[108:111], v10 offset:4096
ds_read_b128 a[112:115], v10 offset:8192
v_mfma_f32_32x32x16_bf16 a[48:63], a[120:123], a[124:127], a[48:63]
s_waitcnt vmcnt(9)
ds_read_b64_tr_b16 a[96:97], v8 offset:32768
ds_read_b64_tr_b16 a[98:99], v8 offset:33280
ds_read_b64_tr_b16 a[100:101], v9 offset:32768
ds_read_b64_tr_b16 a[102:103], v9 offset:33280
v_mfma_f32_32x32x16_bf16 a[16:31], a[116:119], a[128:131], a[16:31]
v_mfma_f32_32x32x16_bf16 a[64:79], a[120:123], a[128:131], a[64:79]
v_mfma_f32_32x32x16_bf16 a[32:47], a[116:119], a[132:135], a[32:47]
v_mfma_f32_32x32x16_bf16 a[80:95], a[120:123], a[132:135], a[80:95]
s_waitcnt lgkmcnt(2)
v_mfma_f32_32x32x16_bf16 a[0:15], a[96:99], a[104:107], a[0:15]
v_sub_f32 v44, v136, v24
v_sub_f32 v45, v137, v24
ds_read_b64_tr_b16 a[116:117], v8 offset:34816
v_sub_f32 v46, v138, v24
v_sub_f32 v47, v139, v24
v_exp_f32 v44, v44
ds_read_b64_tr_b16 a[118:119], v8 offset:35328
v_exp_f32 v45, v45
v_exp_f32 v46, v46
s_waitcnt lgkmcnt(2)
v_mfma_f32_32x32x16_bf16 a[48:63], a[100:103], a[104:107], a[48:63]
v_exp_f32 v47, v47
v_add_f32 v30, v30, v44
v_cvt_pk_bf16_f32 v56, v44, v45
ds_read_b128 a[124:127], v11 offset:0
v_add_f32 v30, v30, v45
s_mov_b32 m0, s33
s_mov_b32 s5, 131072
buffer_load_dwordx4 v3, s[20:23], s5 offen nt lds
v_cvt_pk_bf16_f32 v57, v46, v47
ds_read_b64_tr_b16 a[120:121], v9 offset:34816
v_add_f32 v30, v30, v46
v_add_f32 v30, v30, v47
v_mfma_f32_32x32x16_bf16 a[16:31], a[96:99], a[108:111], a[16:31]
ds_write_b64 v18, v[56:57] offset:12288
v_sub_f32 v48, v140, v25
v_sub_f32 v49, v141, v25
ds_read_b64_tr_b16 a[122:123], v9 offset:35328
v_sub_f32 v50, v142, v25
v_sub_f32 v51, v143, v25
ds_read_b128 a[128:131], v11 offset:4096
v_exp_f32 v48, v48
v_exp_f32 v49, v49
buffer_load_dwordx4 v41, s[20:23], s5 offen offset:1024 nt lds
v_mfma_f32_32x32x16_bf16 a[64:79], a[100:103], a[108:111], a[64:79]
v_exp_f32 v50, v50
v_exp_f32 v51, v51
v_add_f32 v31, v31, v48
ds_read_b128 a[132:135], v11 offset:8192
v_cvt_pk_bf16_f32 v58, v48, v49
v_add_f32 v31, v31, v49
v_mfma_f32_32x32x16_bf16 a[32:47], a[96:99], a[112:115], a[32:47]
v_cvt_pk_bf16_f32 v59, v50, v51
v_add_f32 v31, v31, v50
v_add_f32 v31, v31, v51
v_mfma_f32_32x32x16_bf16 a[80:95], a[100:103], a[112:115], a[80:95]
ds_write_b64 v18, v[58:59] offset:14336
v_sub_f32 v44, v144, v26
s_waitcnt lgkmcnt(6)
v_mfma_f32_32x32x16_bf16 a[0:15], a[116:119], a[124:127], a[0:15]
buffer_load_dwordx4 v42, s[20:23], s5 offen offset:2048 nt lds
v_sub_f32 v45, v145, v26
v_sub_f32 v46, v146, v26
ds_read_b64_tr_b16 a[96:97], v8 offset:36864
v_sub_f32 v47, v147, v26
v_exp_f32 v44, v44
v_exp_f32 v45, v45
ds_read_b64_tr_b16 a[98:99], v8 offset:37376
v_exp_f32 v46, v46
v_exp_f32 v47, v47
s_waitcnt lgkmcnt(5)
v_mfma_f32_32x32x16_bf16 a[48:63], a[120:123], a[124:127], a[48:63]
v_add_f32 v32, v32, v44
v_cvt_pk_bf16_f32 v56, v44, v45
v_add_f32 v32, v32, v45
ds_read_b128 a[104:107], v12 offset:0
buffer_load_dwordx4 v43, s[20:23], s5 offen offset:3072 nt lds
v_cvt_pk_bf16_f32 v57, v46, v47
ds_read_b64_tr_b16 a[100:101], v9 offset:36864
v_add_f32 v32, v32, v46
v_add_f32 v32, v32, v47
ds_write_b64 v18, v[56:57] offset:16384
s_waitcnt lgkmcnt(7)
v_mfma_f32_32x32x16_bf16 a[16:31], a[116:119], a[128:131], a[16:31]
v_sub_f32 v48, v148, v27
v_sub_f32 v49, v149, v27
v_sub_f32 v50, v150, v27
ds_read_b64_tr_b16 a[102:103], v9 offset:37376
v_sub_f32 v51, v151, v27
v_exp_f32 v48, v48
ds_read_b128 a[108:111], v12 offset:4096
v_exp_f32 v49, v49
s_add_u32 m0, s33, 4096
s_mov_b32 s5, 147456
buffer_load_dwordx4 v3, s[20:23], s5 offen nt lds
v_exp_f32 v50, v50
v_mfma_f32_32x32x16_bf16 a[64:79], a[120:123], a[128:131], a[64:79]
v_exp_f32 v51, v51
v_add_f32 v33, v33, v48
ds_read_b128 a[112:115], v12 offset:8192
v_cvt_pk_bf16_f32 v58, v48, v49
v_add_f32 v33, v33, v49
v_cvt_pk_bf16_f32 v59, v50, v51
s_waitcnt lgkmcnt(9)
v_mfma_f32_32x32x16_bf16 a[32:47], a[116:119], a[132:135], a[32:47]
v_add_f32 v33, v33, v50
v_add_f32 v33, v33, v51
ds_write_b64 v18, v[58:59] offset:18432
v_mfma_f32_32x32x16_bf16 a[80:95], a[120:123], a[132:135], a[80:95]
v_sub_f32 v44, v152, v28
buffer_load_dwordx4 v41, s[20:23], s5 offen offset:1024 nt lds
s_waitcnt lgkmcnt(6)
v_mfma_f32_32x32x16_bf16 a[0:15], a[96:99], a[104:107], a[0:15]
v_sub_f32 v45, v153, v28
v_sub_f32 v46, v154, v28
v_sub_f32 v47, v155, v28
ds_read_b64_tr_b16 a[116:117], v8 offset:38912
v_exp_f32 v44, v44
v_exp_f32 v45, v45
ds_read_b64_tr_b16 a[118:119], v8 offset:39424
v_exp_f32 v46, v46
v_exp_f32 v47, v47
v_add_f32 v34, v34, v44
s_waitcnt lgkmcnt(5)
v_mfma_f32_32x32x16_bf16 a[48:63], a[100:103], a[104:107], a[48:63]
v_cvt_pk_bf16_f32 v56, v44, v45
v_add_f32 v34, v34, v45
buffer_load_dwordx4 v42, s[20:23], s5 offen offset:2048 nt lds
ds_read_b128 a[124:127], v13 offset:0
v_cvt_pk_bf16_f32 v57, v46, v47
v_add_f32 v34, v34, v46
ds_read_b64_tr_b16 a[120:121], v9 offset:38912
v_add_f32 v34, v34, v47
ds_write_b64 v18, v[56:57] offset:20480
v_sub_f32 v48, v156, v29
s_waitcnt lgkmcnt(7)
v_mfma_f32_32x32x16_bf16 a[16:31], a[96:99], a[108:111], a[16:31]
v_sub_f32 v49, v157, v29
v_sub_f32 v50, v158, v29
ds_read_b64_tr_b16 a[122:123], v9 offset:39424
v_sub_f32 v51, v159, v29
v_exp_f32 v48, v48
v_exp_f32 v49, v49
ds_read_b128 a[128:131], v13 offset:4096
buffer_load_dwordx4 v43, s[20:23], s5 offen offset:3072 nt lds
v_exp_f32 v50, v50
v_exp_f32 v51, v51
v_mfma_f32_32x32x16_bf16 a[64:79], a[100:103], a[108:111], a[64:79]
v_add_f32 v35, v35, v48
v_cvt_pk_bf16_f32 v58, v48, v49
ds_read_b128 a[132:135], v13 offset:8192
v_add_f32 v35, v35, v49
v_cvt_pk_bf16_f32 v59, v50, v51
v_add_f32 v35, v35, v50
s_waitcnt lgkmcnt(9)
v_mfma_f32_32x32x16_bf16 a[32:47], a[96:99], a[112:115], a[32:47]
v_add_f32 v35, v35, v51
ds_write_b64 v18, v[58:59] offset:22528
v_mfma_f32_32x32x16_bf16 a[80:95], a[100:103], a[112:115], a[80:95]
s_waitcnt lgkmcnt(0)
s_barrier
v_mfma_f32_32x32x16_bf16 a[0:15], a[116:119], a[124:127], a[0:15]
ds_read_b128 a[104:107], v10 offset:12288
ds_read_b128 a[108:111], v10 offset:16384
ds_read_b128 a[112:115], v10 offset:20480
v_mfma_f32_32x32x16_bf16 a[48:63], a[120:123], a[124:127], a[48:63]
s_waitcnt vmcnt(8)
ds_read_b64_tr_b16 a[96:97], v38 offset:0
ds_read_b64_tr_b16 a[98:99], v38 offset:512
ds_read_b64_tr_b16 a[100:101], v39 offset:0
ds_read_b64_tr_b16 a[102:103], v39 offset:512
v_mfma_f32_32x32x16_bf16 a[16:31], a[116:119], a[128:131], a[16:31]
v_mfma_f32_32x32x16_bf16 a[64:79], a[120:123], a[128:131], a[64:79]
v_mfma_f32_32x32x16_bf16 a[32:47], a[116:119], a[132:135], a[32:47]
v_mfma_f32_32x32x16_bf16 a[80:95], a[120:123], a[132:135], a[80:95]
s_waitcnt lgkmcnt(2)
v_mfma_f32_32x32x16_bf16 a[0:15], a[96:99], a[104:107], a[0:15]
v_sub_f32 v44, v160, v24
v_sub_f32 v45, v161, v24
ds_read_b64_tr_b16 a[116:117], v38 offset:2048
v_sub_f32 v46, v162, v24
v_sub_f32 v47, v163, v24
v_exp_f32 v44, v44
ds_read_b64_tr_b16 a[118:119], v38 offset:2560
v_exp_f32 v45, v45
v_exp_f32 v46, v46
s_waitcnt lgkmcnt(2)
v_mfma_f32_32x32x16_bf16 a[48:63], a[100:103], a[104:107], a[48:63]
v_exp_f32 v47, v47
v_add_f32 v30, v30, v44
v_cvt_pk_bf16_f32 v56, v44, v45
ds_read_b128 a[124:127], v11 offset:12288
v_add_f32 v30, v30, v45
s_add_u32 m0, s33, 32768
s_mov_b32 s5, 163840
buffer_load_dwordx4 v3, s[20:23], s5 offen nt lds
v_cvt_pk_bf16_f32 v57, v46, v47
ds_read_b64_tr_b16 a[120:121], v39 offset:2048
v_add_f32 v30, v30, v46
v_add_f32 v30, v30, v47
v_mfma_f32_32x32x16_bf16 a[16:31], a[96:99], a[108:111], a[16:31]
ds_write_b64 v18, v[56:57] offset:0
v_sub_f32 v48, v164, v25
v_sub_f32 v49, v165, v25
ds_read_b64_tr_b16 a[122:123], v39 offset:2560
v_sub_f32 v50, v166, v25
v_sub_f32 v51, v167, v25
ds_read_b128 a[128:131], v11 offset:16384
v_exp_f32 v48, v48
v_exp_f32 v49, v49
buffer_load_dwordx4 v41, s[20:23], s5 offen offset:1024 nt lds
v_mfma_f32_32x32x16_bf16 a[64:79], a[100:103], a[108:111], a[64:79]
v_exp_f32 v50, v50
v_exp_f32 v51, v51
v_add_f32 v31, v31, v48
ds_read_b128 a[132:135], v11 offset:20480
v_cvt_pk_bf16_f32 v58, v48, v49
v_add_f32 v31, v31, v49
v_mfma_f32_32x32x16_bf16 a[32:47], a[96:99], a[112:115], a[32:47]
v_cvt_pk_bf16_f32 v59, v50, v51
v_add_f32 v31, v31, v50
v_add_f32 v31, v31, v51
v_mfma_f32_32x32x16_bf16 a[80:95], a[100:103], a[112:115], a[80:95]
ds_write_b64 v18, v[58:59] offset:2048
v_sub_f32 v44, v168, v26
s_waitcnt lgkmcnt(6)
v_mfma_f32_32x32x16_bf16 a[0:15], a[116:119], a[124:127], a[0:15]
buffer_load_dwordx4 v42, s[20:23], s5 offen offset:2048 nt lds
v_sub_f32 v45, v169, v26
v_sub_f32 v46, v170, v26
ds_read_b64_tr_b16 a[96:97], v38 offset:4096
v_sub_f32 v47, v171, v26
v_exp_f32 v44, v44
v_exp_f32 v45, v45
ds_read_b64_tr_b16 a[98:99], v38 offset:4608
v_exp_f32 v46, v46
v_exp_f32 v47, v47
s_waitcnt lgkmcnt(5)
v_mfma_f32_32x32x16_bf16 a[48:63], a[120:123], a[124:127], a[48:63]
v_add_f32 v32, v32, v44
v_cvt_pk_bf16_f32 v56, v44, v45
v_add_f32 v32, v32, v45
ds_read_b128 a[104:107], v12 offset:12288
buffer_load_dwordx4 v43, s[20:23], s5 offen offset:3072 nt lds
v_cvt_pk_bf16_f32 v57, v46, v47
ds_read_b64_tr_b16 a[100:101], v39 offset:4096
v_add_f32 v32, v32, v46
v_add_f32 v32, v32, v47
ds_write_b64 v18, v[56:57] offset:4096
s_waitcnt lgkmcnt(7)
v_mfma_f32_32x32x16_bf16 a[16:31], a[116:119], a[128:131], a[16:31]
v_sub_f32 v48, v172, v27
v_sub_f32 v49, v173, v27
v_sub_f32 v50, v174, v27
ds_read_b64_tr_b16 a[102:103], v39 offset:4608
v_sub_f32 v51, v175, v27
v_exp_f32 v48, v48
ds_read_b128 a[108:111], v12 offset:16384
v_exp_f32 v49, v49
s_add_u32 m0, s33, 36864
s_mov_b32 s5, 180224
buffer_load_dwordx4 v3, s[20:23], s5 offen nt lds
v_exp_f32 v50, v50
v_mfma_f32_32x32x16_bf16 a[64:79], a[120:123], a[128:131], a[64:79]
v_exp_f32 v51, v51
v_add_f32 v33, v33, v48
ds_read_b128 a[112:115], v12 offset:20480
v_cvt_pk_bf16_f32 v58, v48, v49
v_add_f32 v33, v33, v49
v_cvt_pk_bf16_f32 v59, v50, v51
s_waitcnt lgkmcnt(9)
v_mfma_f32_32x32x16_bf16 a[32:47], a[116:119], a[132:135], a[32:47]
v_add_f32 v33, v33, v50
v_add_f32 v33, v33, v51
ds_write_b64 v18, v[58:59] offset:6144
v_mfma_f32_32x32x16_bf16 a[80:95], a[120:123], a[132:135], a[80:95]
v_sub_f32 v44, v176, v28
buffer_load_dwordx4 v41, s[20:23], s5 offen offset:1024 nt lds
s_waitcnt lgkmcnt(6)
v_mfma_f32_32x32x16_bf16 a[0:15], a[96:99], a[104:107], a[0:15]
v_sub_f32 v45, v177, v28
v_sub_f32 v46, v178, v28
v_sub_f32 v47, v179, v28
ds_read_b64_tr_b16 a[116:117], v38 offset:6144
v_exp_f32 v44, v44
v_exp_f32 v45, v45
ds_read_b64_tr_b16 a[118:119], v38 offset:6656
v_exp_f32 v46, v46
v_exp_f32 v47, v47
v_add_f32 v34, v34, v44
s_waitcnt lgkmcnt(5)
v_mfma_f32_32x32x16_bf16 a[48:63], a[100:103], a[104:107], a[48:63]
v_cvt_pk_bf16_f32 v56, v44, v45
v_add_f32 v34, v34, v45
buffer_load_dwordx4 v42, s[20:23], s5 offen offset:2048 nt lds
ds_read_b128 a[124:127], v13 offset:12288
v_cvt_pk_bf16_f32 v57, v46, v47
v_add_f32 v34, v34, v46
ds_read_b64_tr_b16 a[120:121], v39 offset:6144
v_add_f32 v34, v34, v47
ds_write_b64 v18, v[56:57] offset:8192
v_sub_f32 v48, v180, v29
s_waitcnt lgkmcnt(7)
v_mfma_f32_32x32x16_bf16 a[16:31], a[96:99], a[108:111], a[16:31]
v_sub_f32 v49, v181, v29
v_sub_f32 v50, v182, v29
ds_read_b64_tr_b16 a[122:123], v39 offset:6656
v_sub_f32 v51, v183, v29
v_exp_f32 v48, v48
v_exp_f32 v49, v49
ds_read_b128 a[128:131], v13 offset:16384
buffer_load_dwordx4 v43, s[20:23], s5 offen offset:3072 nt lds
v_exp_f32 v50, v50
v_exp_f32 v51, v51
v_mfma_f32_32x32x16_bf16 a[64:79], a[100:103], a[108:111], a[64:79]
v_add_f32 v35, v35, v48
v_cvt_pk_bf16_f32 v58, v48, v49
ds_read_b128 a[132:135], v13 offset:20480
v_add_f32 v35, v35, v49
v_cvt_pk_bf16_f32 v59, v50, v51
v_add_f32 v35, v35, v50
s_waitcnt lgkmcnt(9)
v_mfma_f32_32x32x16_bf16 a[32:47], a[96:99], a[112:115], a[32:47]
v_add_f32 v35, v35, v51
ds_write_b64 v18, v[58:59] offset:10240
v_mfma_f32_32x32x16_bf16 a[80:95], a[100:103], a[112:115], a[80:95]
s_waitcnt lgkmcnt(0)
s_barrier
v_mfma_f32_32x32x16_bf16 a[0:15], a[116:119], a[124:127], a[0:15]
ds_read_b128 a[104:107], v10 offset:0
ds_read_b128 a[108:111], v10 offset:4096
ds_read_b128 a[112:115], v10 offset:8192
v_mfma_f32_32x32x16_bf16 a[48:63], a[120:123], a[124:127], a[48:63]
s_waitcnt vmcnt(8)
ds_read_b64_tr_b16 a[96:97], v8 offset:0
ds_read_b64_tr_b16 a[98:99], v8 offset:512
ds_read_b64_tr_b16 a[100:101], v9 offset:0
ds_read_b64_tr_b16 a[102:103], v9 offset:512
v_mfma_f32_32x32x16_bf16 a[16:31], a[116:119], a[128:131], a[16:31]
v_mfma_f32_32x32x16_bf16 a[64:79], a[120:123], a[128:131], a[64:79]
v_mfma_f32_32x32x16_bf16 a[32:47], a[116:119], a[132:135], a[32:47]
v_mfma_f32_32x32x16_bf16 a[80:95], a[120:123], a[132:135], a[80:95]
v_accvgpr_read_b32 v64, a0
v_accvgpr_read_b32 v65, a1
v_accvgpr_read_b32 v66, a2
v_accvgpr_read_b32 v67, a3
v_accvgpr_read_b32 v68, a4
v_accvgpr_read_b32 v69, a5
v_accvgpr_read_b32 v70, a6
v_accvgpr_read_b32 v71, a7
v_accvgpr_read_b32 v72, a8
v_accvgpr_read_b32 v73, a9
v_accvgpr_read_b32 v74, a10
v_accvgpr_read_b32 v75, a11
v_accvgpr_read_b32 v76, a12
v_accvgpr_read_b32 v77, a13
v_accvgpr_read_b32 v78, a14
v_accvgpr_read_b32 v79, a15
v_accvgpr_read_b32 v80, a16
v_accvgpr_read_b32 v81, a17
v_accvgpr_read_b32 v82, a18
v_accvgpr_read_b32 v83, a19
s_add_u32 m0, s33, 65536
s_mov_b32 s5, 196608
buffer_load_dwordx4 v3, s[20:23], s5 offen nt lds
v_accvgpr_read_b32 v84, a20
v_accvgpr_read_b32 v85, a21
v_accvgpr_read_b32 v86, a22
v_accvgpr_read_b32 v87, a23
v_accvgpr_read_b32 v88, a24
v_accvgpr_read_b32 v89, a25
v_accvgpr_read_b32 v90, a26
v_accvgpr_read_b32 v91, a27
v_accvgpr_read_b32 v92, a28
v_accvgpr_read_b32 v93, a29
v_accvgpr_read_b32 v94, a30
v_accvgpr_read_b32 v95, a31
v_accvgpr_read_b32 v96, a32
v_accvgpr_read_b32 v97, a33
v_accvgpr_read_b32 v98, a34
v_accvgpr_read_b32 v99, a35
v_accvgpr_read_b32 v100, a36
v_accvgpr_read_b32 v101, a37
v_accvgpr_read_b32 v102, a38
buffer_load_dwordx4 v41, s[20:23], s5 offen offset:1024 nt lds
v_accvgpr_read_b32 v103, a39
v_accvgpr_read_b32 v104, a40
v_accvgpr_read_b32 v105, a41
v_accvgpr_read_b32 v106, a42
v_accvgpr_read_b32 v107, a43
v_accvgpr_read_b32 v108, a44
v_accvgpr_read_b32 v109, a45
v_accvgpr_read_b32 v110, a46
v_accvgpr_read_b32 v111, a47
v_accvgpr_read_b32 v112, a48
v_accvgpr_read_b32 v113, a49
v_accvgpr_read_b32 v114, a50
v_accvgpr_read_b32 v115, a51
v_accvgpr_read_b32 v116, a52
v_accvgpr_read_b32 v117, a53
v_accvgpr_read_b32 v118, a54
v_accvgpr_read_b32 v119, a55
v_accvgpr_read_b32 v120, a56
v_accvgpr_read_b32 v121, a57
buffer_load_dwordx4 v42, s[20:23], s5 offen offset:2048 nt lds
v_accvgpr_read_b32 v122, a58
v_accvgpr_read_b32 v123, a59
v_accvgpr_read_b32 v124, a60
v_accvgpr_read_b32 v125, a61
v_accvgpr_read_b32 v126, a62
v_accvgpr_read_b32 v127, a63
v_accvgpr_read_b32 v128, a64
v_accvgpr_read_b32 v129, a65
v_accvgpr_read_b32 v130, a66
v_accvgpr_read_b32 v131, a67
v_accvgpr_read_b32 v132, a68
v_accvgpr_read_b32 v133, a69
v_accvgpr_read_b32 v134, a70
v_accvgpr_read_b32 v135, a71
v_accvgpr_read_b32 v136, a72
v_accvgpr_read_b32 v137, a73
v_accvgpr_read_b32 v138, a74
v_accvgpr_read_b32 v139, a75
v_accvgpr_read_b32 v140, a76
buffer_load_dwordx4 v43, s[20:23], s5 offen offset:3072 nt lds
v_accvgpr_read_b32 v141, a77
v_accvgpr_read_b32 v142, a78
v_accvgpr_read_b32 v143, a79
v_accvgpr_read_b32 v144, a80
v_accvgpr_read_b32 v145, a81
v_accvgpr_read_b32 v146, a82
v_accvgpr_read_b32 v147, a83
v_accvgpr_read_b32 v148, a84
v_accvgpr_read_b32 v149, a85
v_accvgpr_read_b32 v150, a86
v_accvgpr_read_b32 v151, a87
v_accvgpr_read_b32 v152, a88
v_accvgpr_read_b32 v153, a89
v_accvgpr_read_b32 v154, a90
v_accvgpr_read_b32 v155, a91
v_accvgpr_read_b32 v156, a92
v_accvgpr_read_b32 v157, a93
v_accvgpr_read_b32 v158, a94
v_accvgpr_read_b32 v159, a95
s_waitcnt lgkmcnt(2)
v_mfma_f32_32x32x16_bf16 v[64:79], a[96:99], a[104:107], v[64:79]
v_sub_f32 v44, v184, v24
s_add_u32 m0, s33, 69632
s_mov_b32 s5, 212992
buffer_load_dwordx4 v3, s[20:23], s5 offen nt lds
v_sub_f32 v45, v185, v24
ds_read_b64_tr_b16 a[116:117], v8 offset:2048
v_sub_f32 v46, v186, v24
v_sub_f32 v47, v187, v24
ds_read_b64_tr_b16 a[118:119], v8 offset:2560
v_exp_f32 v44, v44
v_exp_f32 v45, v45
v_exp_f32 v46, v46
s_waitcnt lgkmcnt(2)
v_mfma_f32_32x32x16_bf16 v[112:127], a[100:103], a[104:107], v[112:127]
v_exp_f32 v47, v47
v_add_f32 v30, v30, v44
ds_read_b128 a[124:127], v11 offset:0
v_cvt_pk_bf16_f32 v56, v44, v45
v_add_f32 v30, v30, v45
v_cvt_pk_bf16_f32 v57, v46, v47
ds_read_b64_tr_b16 a[120:121], v9 offset:2048
v_add_f32 v30, v30, v46
v_add_f32 v30, v30, v47
v_mfma_f32_32x32x16_bf16 v[80:95], a[96:99], a[108:111], v[80:95]
ds_write_b64 v18, v[56:57] offset:12288
v_sub_f32 v48, v188, v25
v_sub_f32 v49, v189, v25
ds_read_b64_tr_b16 a[122:123], v9 offset:2560
v_sub_f32 v50, v190, v25
v_sub_f32 v51, v191, v25
ds_read_b128 a[128:131], v11 offset:4096
v_exp_f32 v48, v48
v_exp_f32 v49, v49
v_exp_f32 v50, v50
v_mfma_f32_32x32x16_bf16 v[128:143], a[100:103], a[108:111], v[128:143]
v_exp_f32 v51, v51
buffer_load_dwordx4 v41, s[20:23], s5 offen offset:1024 nt lds
ds_read_b128 a[132:135], v11 offset:8192
v_add_f32 v31, v31, v48
v_cvt_pk_bf16_f32 v58, v48, v49
v_add_f32 v31, v31, v49
v_mfma_f32_32x32x16_bf16 v[96:111], a[96:99], a[112:115], v[96:111]
v_cvt_pk_bf16_f32 v59, v50, v51
v_add_f32 v31, v31, v50
v_mfma_f32_32x32x16_bf16 v[144:159], a[100:103], a[112:115], v[144:159]
v_add_f32 v31, v31, v51
ds_write_b64 v18, v[58:59] offset:14336
v_sub_f32 v44, v192, v26
s_waitcnt lgkmcnt(6)
v_mfma_f32_32x32x16_bf16 v[64:79], a[116:119], a[124:127], v[64:79]
v_sub_f32 v45, v193, v26
v_sub_f32 v46, v194, v26
ds_read_b64_tr_b16 a[96:97], v8 offset:4096
v_sub_f32 v47, v195, v26
v_exp_f32 v44, v44
v_exp_f32 v45, v45
ds_read_b64_tr_b16 a[98:99], v8 offset:4608
v_exp_f32 v46, v46
v_exp_f32 v47, v47
s_waitcnt lgkmcnt(5)
v_mfma_f32_32x32x16_bf16 v[112:127], a[120:123], a[124:127], v[112:127]
v_add_f32 v32, v32, v44
v_cvt_pk_bf16_f32 v56, v44, v45
v_add_f32 v32, v32, v45
ds_read_b128 a[104:107], v12 offset:0
v_cvt_pk_bf16_f32 v57, v46, v47
v_add_f32 v32, v32, v46
ds_read_b64_tr_b16 a[100:101], v9 offset:4096
v_add_f32 v32, v32, v47
ds_write_b64 v18, v[56:57] offset:16384
s_waitcnt lgkmcnt(7)
v_mfma_f32_32x32x16_bf16 v[80:95], a[116:119], a[128:131], v[80:95]
v_sub_f32 v48, v196, v27
buffer_load_dwordx4 v42, s[20:23], s5 offen offset:2048 nt lds
v_sub_f32 v49, v197, v27
ds_read_b64_tr_b16 a[102:103], v9 offset:4608
v_sub_f32 v50, v198, v27
v_sub_f32 v51, v199, v27
ds_read_b128 a[108:111], v12 offset:4096
v_exp_f32 v48, v48
v_exp_f32 v49, v49
v_exp_f32 v50, v50
v_mfma_f32_32x32x16_bf16 v[128:143], a[120:123], a[128:131], v[128:143]
v_exp_f32 v51, v51
v_add_f32 v33, v33, v48
ds_read_b128 a[112:115], v12 offset:8192
v_cvt_pk_bf16_f32 v58, v48, v49
v_add_f32 v33, v33, v49
v_cvt_pk_bf16_f32 v59, v50, v51
s_waitcnt lgkmcnt(9)
v_mfma_f32_32x32x16_bf16 v[96:111], a[116:119], a[132:135], v[96:111]
v_add_f32 v33, v33, v50
v_add_f32 v33, v33, v51
v_mfma_f32_32x32x16_bf16 v[144:159], a[120:123], a[132:135], v[144:159]
ds_write_b64 v18, v[58:59] offset:18432
v_sub_f32 v44, v200, v28
v_sub_f32 v45, v201, v28
s_waitcnt lgkmcnt(6)
v_mfma_f32_32x32x16_bf16 v[64:79], a[96:99], a[104:107], v[64:79]
v_sub_f32 v46, v202, v28
v_sub_f32 v47, v203, v28
ds_read_b64_tr_b16 a[116:117], v8 offset:6144
v_exp_f32 v44, v44
v_exp_f32 v45, v45
v_exp_f32 v46, v46
ds_read_b64_tr_b16 a[118:119], v8 offset:6656
v_exp_f32 v47, v47
buffer_load_dwordx4 v43, s[20:23], s5 offen offset:3072 nt lds
s_waitcnt lgkmcnt(5)
v_mfma_f32_32x32x16_bf16 v[112:127], a[100:103], a[104:107], v[112:127]
v_add_f32 v34, v34, v44
v_cvt_pk_bf16_f32 v56, v44, v45
v_add_f32 v34, v34, v45
ds_read_b128 a[124:127], v13 offset:0
v_cvt_pk_bf16_f32 v57, v46, v47
v_add_f32 v34, v34, v46
ds_read_b64_tr_b16 a[120:121], v9 offset:6144
v_add_f32 v34, v34, v47
ds_write_b64 v18, v[56:57] offset:20480
v_sub_f32 v48, v204, v29
s_waitcnt lgkmcnt(7)
v_mfma_f32_32x32x16_bf16 v[80:95], a[96:99], a[108:111], v[80:95]
v_sub_f32 v49, v205, v29
v_sub_f32 v50, v206, v29
ds_read_b64_tr_b16 a[122:123], v9 offset:6656
v_sub_f32 v51, v207, v29
v_exp_f32 v48, v48
v_exp_f32 v49, v49
ds_read_b128 a[128:131], v13 offset:4096
v_exp_f32 v50, v50
v_exp_f32 v51, v51
v_mfma_f32_32x32x16_bf16 v[128:143], a[100:103], a[108:111], v[128:143]
v_add_f32 v35, v35, v48
v_cvt_pk_bf16_f32 v58, v48, v49
v_add_f32 v35, v35, v49
ds_read_b128 a[132:135], v13 offset:8192
v_cvt_pk_bf16_f32 v59, v50, v51
v_add_f32 v35, v35, v50
s_waitcnt lgkmcnt(9)
v_mfma_f32_32x32x16_bf16 v[96:111], a[96:99], a[112:115], v[96:111]
v_add_f32 v35, v35, v51
ds_write_b64 v18, v[58:59] offset:22528
v_mfma_f32_32x32x16_bf16 v[144:159], a[100:103], a[112:115], v[144:159]
s_waitcnt lgkmcnt(0)
s_barrier
v_mfma_f32_32x32x16_bf16 v[64:79], a[116:119], a[124:127], v[64:79]
ds_read_b128 a[104:107], v10 offset:12288
ds_read_b128 a[108:111], v10 offset:16384
ds_read_b128 a[112:115], v10 offset:20480
v_mfma_f32_32x32x16_bf16 v[112:127], a[120:123], a[124:127], v[112:127]
s_waitcnt vmcnt(8)
ds_read_b64_tr_b16 a[96:97], v8 offset:32768
ds_read_b64_tr_b16 a[98:99], v8 offset:33280
ds_read_b64_tr_b16 a[100:101], v9 offset:32768
ds_read_b64_tr_b16 a[102:103], v9 offset:33280
v_mfma_f32_32x32x16_bf16 v[80:95], a[116:119], a[128:131], v[80:95]
v_lshrrev_b32 v168, 3, v0
s_lshl_b32 s6, s3, 6
v_add_u32 v168, s6, v168
v_mul_u32_u24 v168, 896, v168
v_lshrrev_b32 v169, 4, v0
v_and_b32 v169, 1, v169
v_mfma_f32_32x32x16_bf16 v[128:143], a[120:123], a[128:131], v[128:143]
v_lshlrev_b32 v169, 1, v169
v_and_b32 v170, 7, v0
v_xor_b32 v169, v169, v170
v_lshlrev_b32 v169, 4, v169
v_add_u32 v170, v168, v169
v_mfma_f32_32x32x16_bf16 v[96:111], a[116:119], a[132:135], v[96:111]
v_xor_b32 v169, 64, v169
v_add_u32 v169, v168, v169
v_add_u32 v160, 0, v170
v_add_u32 v161, 6144, v169
v_add_u32 v162, 12288, v170
v_mfma_f32_32x32x16_bf16 v[144:159], a[120:123], a[132:135], v[144:159]
v_add_u32 v163, 18432, v169
v_add_u32 v164, 28672, v170
v_add_u32 v165, 34816, v169
v_add_u32 v166, 40960, v170
v_add_u32 v167, 47104, v169
s_waitcnt lgkmcnt(2)
v_mfma_f32_32x32x16_bf16 v[64:79], a[96:99], a[104:107], v[64:79]
v_sub_f32 v44, v208, v24
v_sub_f32 v45, v209, v24
ds_read_b64_tr_b16 a[116:117], v8 offset:34816
v_sub_f32 v46, v210, v24
v_sub_f32 v47, v211, v24
v_exp_f32 v44, v44
ds_read_b64_tr_b16 a[118:119], v8 offset:35328
v_exp_f32 v45, v45
v_exp_f32 v46, v46
s_waitcnt lgkmcnt(2)
v_mfma_f32_32x32x16_bf16 v[112:127], a[100:103], a[104:107], v[112:127]
v_exp_f32 v47, v47
v_add_f32 v30, v30, v44
v_cvt_pk_bf16_f32 v56, v44, v45
ds_read_b128 a[124:127], v11 offset:12288
v_add_f32 v30, v30, v45
s_mov_b32 m0, s33
s_mov_b32 s5, 229376
buffer_load_dwordx4 v3, s[20:23], s5 offen nt lds
v_cvt_pk_bf16_f32 v57, v46, v47
ds_read_b64_tr_b16 a[120:121], v9 offset:34816
v_add_f32 v30, v30, v46
v_add_f32 v30, v30, v47
v_mfma_f32_32x32x16_bf16 v[80:95], a[96:99], a[108:111], v[80:95]
ds_write_b64 v18, v[56:57] offset:0
v_sub_f32 v48, v212, v25
v_sub_f32 v49, v213, v25
ds_read_b64_tr_b16 a[122:123], v9 offset:35328
v_sub_f32 v50, v214, v25
v_sub_f32 v51, v215, v25
ds_read_b128 a[128:131], v11 offset:16384
v_exp_f32 v48, v48
v_exp_f32 v49, v49
buffer_load_dwordx4 v41, s[20:23], s5 offen offset:1024 nt lds
v_mfma_f32_32x32x16_bf16 v[128:143], a[100:103], a[108:111], v[128:143]
v_exp_f32 v50, v50
v_exp_f32 v51, v51
v_add_f32 v31, v31, v48
ds_read_b128 a[132:135], v11 offset:20480
v_cvt_pk_bf16_f32 v58, v48, v49
v_add_f32 v31, v31, v49
v_mfma_f32_32x32x16_bf16 v[96:111], a[96:99], a[112:115], v[96:111]
v_cvt_pk_bf16_f32 v59, v50, v51
v_add_f32 v31, v31, v50
v_add_f32 v31, v31, v51
v_mfma_f32_32x32x16_bf16 v[144:159], a[100:103], a[112:115], v[144:159]
ds_write_b64 v18, v[58:59] offset:2048
v_sub_f32 v44, v216, v26
s_waitcnt lgkmcnt(6)
v_mfma_f32_32x32x16_bf16 v[64:79], a[116:119], a[124:127], v[64:79]
buffer_load_dwordx4 v42, s[20:23], s5 offen offset:2048 nt lds
v_sub_f32 v45, v217, v26
v_sub_f32 v46, v218, v26
ds_read_b64_tr_b16 a[96:97], v8 offset:36864
v_sub_f32 v47, v219, v26
v_exp_f32 v44, v44
v_exp_f32 v45, v45
ds_read_b64_tr_b16 a[98:99], v8 offset:37376
v_exp_f32 v46, v46
v_exp_f32 v47, v47
s_waitcnt lgkmcnt(5)
v_mfma_f32_32x32x16_bf16 v[112:127], a[120:123], a[124:127], v[112:127]
v_add_f32 v32, v32, v44
v_cvt_pk_bf16_f32 v56, v44, v45
v_add_f32 v32, v32, v45
ds_read_b128 a[104:107], v12 offset:12288
buffer_load_dwordx4 v43, s[20:23], s5 offen offset:3072 nt lds
v_cvt_pk_bf16_f32 v57, v46, v47
ds_read_b64_tr_b16 a[100:101], v9 offset:36864
v_add_f32 v32, v32, v46
v_add_f32 v32, v32, v47
ds_write_b64 v18, v[56:57] offset:4096
s_waitcnt lgkmcnt(7)
v_mfma_f32_32x32x16_bf16 v[80:95], a[116:119], a[128:131], v[80:95]
v_sub_f32 v48, v220, v27
v_sub_f32 v49, v221, v27
v_sub_f32 v50, v222, v27
ds_read_b64_tr_b16 a[102:103], v9 offset:37376
v_sub_f32 v51, v223, v27
v_exp_f32 v48, v48
ds_read_b128 a[108:111], v12 offset:16384
v_exp_f32 v49, v49
s_add_u32 m0, s33, 4096
s_mov_b32 s5, 245760
buffer_load_dwordx4 v3, s[20:23], s5 offen nt lds
v_exp_f32 v50, v50
v_mfma_f32_32x32x16_bf16 v[128:143], a[120:123], a[128:131], v[128:143]
v_exp_f32 v51, v51
v_add_f32 v33, v33, v48
ds_read_b128 a[112:115], v12 offset:20480
v_cvt_pk_bf16_f32 v58, v48, v49
v_add_f32 v33, v33, v49
v_cvt_pk_bf16_f32 v59, v50, v51
s_waitcnt lgkmcnt(9)
v_mfma_f32_32x32x16_bf16 v[96:111], a[116:119], a[132:135], v[96:111]
v_add_f32 v33, v33, v50
v_add_f32 v33, v33, v51
ds_write_b64 v18, v[58:59] offset:6144
v_mfma_f32_32x32x16_bf16 v[144:159], a[120:123], a[132:135], v[144:159]
v_sub_f32 v44, v224, v28
buffer_load_dwordx4 v41, s[20:23], s5 offen offset:1024 nt lds
s_waitcnt lgkmcnt(6)
v_mfma_f32_32x32x16_bf16 v[64:79], a[96:99], a[104:107], v[64:79]
v_sub_f32 v45, v225, v28
v_sub_f32 v46, v226, v28
v_sub_f32 v47, v227, v28
ds_read_b64_tr_b16 a[116:117], v8 offset:38912
v_exp_f32 v44, v44
v_exp_f32 v45, v45
ds_read_b64_tr_b16 a[118:119], v8 offset:39424
v_exp_f32 v46, v46
v_exp_f32 v47, v47
v_add_f32 v34, v34, v44
s_waitcnt lgkmcnt(5)
v_mfma_f32_32x32x16_bf16 v[112:127], a[100:103], a[104:107], v[112:127]
v_cvt_pk_bf16_f32 v56, v44, v45
v_add_f32 v34, v34, v45
buffer_load_dwordx4 v42, s[20:23], s5 offen offset:2048 nt lds
ds_read_b128 a[124:127], v13 offset:12288
v_cvt_pk_bf16_f32 v57, v46, v47
v_add_f32 v34, v34, v46
ds_read_b64_tr_b16 a[120:121], v9 offset:38912
v_add_f32 v34, v34, v47
ds_write_b64 v18, v[56:57] offset:8192
v_sub_f32 v48, v228, v29
s_waitcnt lgkmcnt(7)
v_mfma_f32_32x32x16_bf16 v[80:95], a[96:99], a[108:111], v[80:95]
v_sub_f32 v49, v229, v29
v_sub_f32 v50, v230, v29
ds_read_b64_tr_b16 a[122:123], v9 offset:39424
v_sub_f32 v51, v231, v29
v_exp_f32 v48, v48
v_exp_f32 v49, v49
ds_read_b128 a[128:131], v13 offset:16384
buffer_load_dwordx4 v43, s[20:23], s5 offen offset:3072 nt lds
v_exp_f32 v50, v50
v_exp_f32 v51, v51
v_mfma_f32_32x32x16_bf16 v[128:143], a[100:103], a[108:111], v[128:143]
v_add_f32 v35, v35, v48
v_cvt_pk_bf16_f32 v58, v48, v49
ds_read_b128 a[132:135], v13 offset:20480
v_add_f32 v35, v35, v49
v_cvt_pk_bf16_f32 v59, v50, v51
v_add_f32 v35, v35, v50
s_waitcnt lgkmcnt(9)
v_mfma_f32_32x32x16_bf16 v[96:111], a[96:99], a[112:115], v[96:111]
v_add_f32 v35, v35, v51
ds_write_b64 v18, v[58:59] offset:10240
v_mfma_f32_32x32x16_bf16 v[144:159], a[100:103], a[112:115], v[144:159]
s_waitcnt lgkmcnt(0)
s_barrier
v_mfma_f32_32x32x16_bf16 v[64:79], a[116:119], a[124:127], v[64:79]
ds_read_b128 a[104:107], v10 offset:0
ds_read_b128 a[108:111], v10 offset:4096
ds_read_b128 a[112:115], v10 offset:8192
v_mfma_f32_32x32x16_bf16 v[112:127], a[120:123], a[124:127], v[112:127]
s_waitcnt vmcnt(8)
ds_read_b64_tr_b16 a[96:97], v38 offset:0
ds_read_b64_tr_b16 a[98:99], v38 offset:512
ds_read_b64_tr_b16 a[100:101], v39 offset:0
ds_read_b64_tr_b16 a[102:103], v39 offset:512
v_mfma_f32_32x32x16_bf16 v[80:95], a[116:119], a[128:131], v[80:95]
v_mfma_f32_32x32x16_bf16 v[128:143], a[120:123], a[128:131], v[128:143]
v_mfma_f32_32x32x16_bf16 v[96:111], a[116:119], a[132:135], v[96:111]
v_mfma_f32_32x32x16_bf16 v[144:159], a[120:123], a[132:135], v[144:159]
s_waitcnt lgkmcnt(2)
v_mfma_f32_32x32x16_bf16 v[64:79], a[96:99], a[104:107], v[64:79]
v_sub_f32 v44, v232, v24
v_sub_f32 v45, v233, v24
ds_read_b64_tr_b16 a[116:117], v38 offset:2048
v_sub_f32 v46, v234, v24
v_sub_f32 v47, v235, v24
v_exp_f32 v44, v44
ds_read_b64_tr_b16 a[118:119], v38 offset:2560
v_exp_f32 v45, v45
v_exp_f32 v46, v46
s_waitcnt lgkmcnt(2)
v_mfma_f32_32x32x16_bf16 v[112:127], a[100:103], a[104:107], v[112:127]
v_exp_f32 v47, v47
v_add_f32 v30, v30, v44
v_cvt_pk_bf16_f32 v56, v44, v45
ds_read_b128 a[124:127], v11 offset:0
v_add_f32 v30, v30, v45
s_add_u32 m0, s33, 32768
s_nop 0
buffer_load_dwordx4 v160, s[24:27], s36 offen  lds
v_cvt_pk_bf16_f32 v57, v46, v47
ds_read_b64_tr_b16 a[120:121], v39 offset:2048
v_add_f32 v30, v30, v46
v_add_f32 v30, v30, v47
v_mfma_f32_32x32x16_bf16 v[80:95], a[96:99], a[108:111], v[80:95]
ds_write_b64 v18, v[56:57] offset:12288
v_sub_f32 v48, v236, v25
v_sub_f32 v49, v237, v25
ds_read_b64_tr_b16 a[122:123], v39 offset:2560
v_sub_f32 v50, v238, v25
v_sub_f32 v51, v239, v25
ds_read_b128 a[128:131], v11 offset:4096
v_exp_f32 v48, v48
v_exp_f32 v49, v49
buffer_load_dwordx4 v161, s[24:27], s36 offen offset:1024  lds
v_mfma_f32_32x32x16_bf16 v[128:143], a[100:103], a[108:111], v[128:143]
v_exp_f32 v50, v50
v_exp_f32 v51, v51
v_add_f32 v31, v31, v48
ds_read_b128 a[132:135], v11 offset:8192
v_cvt_pk_bf16_f32 v58, v48, v49
v_add_f32 v31, v31, v49
v_mfma_f32_32x32x16_bf16 v[96:111], a[96:99], a[112:115], v[96:111]
v_cvt_pk_bf16_f32 v59, v50, v51
v_add_f32 v31, v31, v50
v_add_f32 v31, v31, v51
v_mfma_f32_32x32x16_bf16 v[144:159], a[100:103], a[112:115], v[144:159]
ds_write_b64 v18, v[58:59] offset:14336
v_sub_f32 v44, v240, v26
s_waitcnt lgkmcnt(6)
v_mfma_f32_32x32x16_bf16 v[64:79], a[116:119], a[124:127], v[64:79]
buffer_load_dwordx4 v162, s[24:27], s36 offen offset:2048  lds
v_sub_f32 v45, v241, v26
v_sub_f32 v46, v242, v26
ds_read_b64_tr_b16 a[96:97], v38 offset:4096
v_sub_f32 v47, v243, v26
v_exp_f32 v44, v44
v_exp_f32 v45, v45
ds_read_b64_tr_b16 a[98:99], v38 offset:4608
v_exp_f32 v46, v46
v_exp_f32 v47, v47
s_waitcnt lgkmcnt(5)
v_mfma_f32_32x32x16_bf16 v[112:127], a[120:123], a[124:127], v[112:127]
v_add_f32 v32, v32, v44
v_cvt_pk_bf16_f32 v56, v44, v45
v_add_f32 v32, v32, v45
ds_read_b128 a[104:107], v12 offset:0
buffer_load_dwordx4 v163, s[24:27], s36 offen offset:3072  lds
v_cvt_pk_bf16_f32 v57, v46, v47
ds_read_b64_tr_b16 a[100:101], v39 offset:4096
v_add_f32 v32, v32, v46
v_add_f32 v32, v32, v47
ds_write_b64 v18, v[56:57] offset:16384
s_waitcnt lgkmcnt(7)
v_mfma_f32_32x32x16_bf16 v[80:95], a[116:119], a[128:131], v[80:95]
v_sub_f32 v48, v244, v27
v_sub_f32 v49, v245, v27
v_sub_f32 v50, v246, v27
ds_read_b64_tr_b16 a[102:103], v39 offset:4608
v_sub_f32 v51, v247, v27
v_exp_f32 v48, v48
ds_read_b128 a[108:111], v12 offset:4096
v_exp_f32 v49, v49
s_add_u32 m0, s33, 36864
s_nop 0
buffer_load_dwordx4 v164, s[24:27], s36 offen  lds
v_exp_f32 v50, v50
v_mfma_f32_32x32x16_bf16 v[128:143], a[120:123], a[128:131], v[128:143]
v_exp_f32 v51, v51
v_add_f32 v33, v33, v48
ds_read_b128 a[112:115], v12 offset:8192
v_cvt_pk_bf16_f32 v58, v48, v49
v_add_f32 v33, v33, v49
v_cvt_pk_bf16_f32 v59, v50, v51
s_waitcnt lgkmcnt(9)
v_mfma_f32_32x32x16_bf16 v[96:111], a[116:119], a[132:135], v[96:111]
v_add_f32 v33, v33, v50
v_add_f32 v33, v33, v51
ds_write_b64 v18, v[58:59] offset:18432
v_mfma_f32_32x32x16_bf16 v[144:159], a[120:123], a[132:135], v[144:159]
v_sub_f32 v44, v248, v28
buffer_load_dwordx4 v165, s[24:27], s36 offen offset:1024  lds
s_waitcnt lgkmcnt(6)
v_mfma_f32_32x32x16_bf16 v[64:79], a[96:99], a[104:107], v[64:79]
v_sub_f32 v45, v249, v28
v_sub_f32 v46, v250, v28
v_sub_f32 v47, v251, v28
ds_read_b64_tr_b16 a[116:117], v38 offset:6144
v_exp_f32 v44, v44
v_exp_f32 v45, v45
ds_read_b64_tr_b16 a[118:119], v38 offset:6656
v_exp_f32 v46, v46
v_exp_f32 v47, v47
v_add_f32 v34, v34, v44
s_waitcnt lgkmcnt(5)
v_mfma_f32_32x32x16_bf16 v[112:127], a[100:103], a[104:107], v[112:127]
v_cvt_pk_bf16_f32 v56, v44, v45
v_add_f32 v34, v34, v45
buffer_load_dwordx4 v166, s[24:27], s36 offen offset:2048  lds
ds_read_b128 a[124:127], v13 offset:0
v_cvt_pk_bf16_f32 v57, v46, v47
v_add_f32 v34, v34, v46
ds_read_b64_tr_b16 a[120:121], v39 offset:6144
v_add_f32 v34, v34, v47
ds_write_b64 v18, v[56:57] offset:20480
v_sub_f32 v48, v252, v29
s_waitcnt lgkmcnt(7)
v_mfma_f32_32x32x16_bf16 v[80:95], a[96:99], a[108:111], v[80:95]
v_sub_f32 v49, v253, v29
v_sub_f32 v50, v254, v29
ds_read_b64_tr_b16 a[122:123], v39 offset:6656
v_sub_f32 v51, v255, v29
v_exp_f32 v48, v48
v_exp_f32 v49, v49
ds_read_b128 a[128:131], v13 offset:4096
buffer_load_dwordx4 v167, s[24:27], s36 offen offset:3072  lds
v_exp_f32 v50, v50
v_exp_f32 v51, v51
v_mfma_f32_32x32x16_bf16 v[128:143], a[100:103], a[108:111], v[128:143]
v_add_f32 v35, v35, v48
v_cvt_pk_bf16_f32 v58, v48, v49
ds_read_b128 a[132:135], v13 offset:8192
v_add_f32 v35, v35, v49
v_cvt_pk_bf16_f32 v59, v50, v51
v_add_f32 v35, v35, v50
s_waitcnt lgkmcnt(9)
v_mfma_f32_32x32x16_bf16 v[96:111], a[96:99], a[112:115], v[96:111]
v_add_f32 v35, v35, v51
ds_write_b64 v18, v[58:59] offset:22528
v_mfma_f32_32x32x16_bf16 v[144:159], a[100:103], a[112:115], v[144:159]
s_waitcnt lgkmcnt(0)
s_barrier
v_mfma_f32_32x32x16_bf16 v[64:79], a[116:119], a[124:127], v[64:79]
ds_read_b128 a[104:107], v10 offset:12288
ds_read_b128 a[108:111], v10 offset:16384
ds_read_b128 a[112:115], v10 offset:20480
v_mfma_f32_32x32x16_bf16 v[112:127], a[120:123], a[124:127], v[112:127]
s_waitcnt vmcnt(8)
ds_read_b64_tr_b16 a[96:97], v8 offset:0
ds_read_b64_tr_b16 a[98:99], v8 offset:512
ds_read_b64_tr_b16 a[100:101], v9 offset:0
ds_read_b64_tr_b16 a[102:103], v9 offset:512
v_mfma_f32_32x32x16_bf16 v[80:95], a[116:119], a[128:131], v[80:95]
v_mfma_f32_32x32x16_bf16 v[128:143], a[120:123], a[128:131], v[128:143]
v_mfma_f32_32x32x16_bf16 v[96:111], a[116:119], a[132:135], v[96:111]
v_mfma_f32_32x32x16_bf16 v[144:159], a[120:123], a[132:135], v[144:159]
s_waitcnt lgkmcnt(2)
v_mfma_f32_32x32x16_bf16 v[64:79], a[96:99], a[104:107], v[64:79]
v_mov_b32 v44, v30
v_mov_b32 v45, v31
ds_read_b64_tr_b16 a[116:117], v8 offset:2048
v_mov_b32 v46, v32
ds_read_b64_tr_b16 a[118:119], v8 offset:2560
v_mov_b32 v47, v33
s_waitcnt lgkmcnt(2)
v_mfma_f32_32x32x16_bf16 v[112:127], a[100:103], a[104:107], v[112:127]
v_mov_b32 v48, v34
ds_read_b128 a[124:127], v11 offset:12288
v_mov_b32 v49, v35
ds_read_b64_tr_b16 a[120:121], v9 offset:2048
v_permlane32_swap_b32 v44, v30
v_mfma_f32_32x32x16_bf16 v[80:95], a[96:99], a[108:111], v[80:95]
v_permlane32_swap_b32 v45, v31
ds_read_b64_tr_b16 a[122:123], v9 offset:2560
v_permlane32_swap_b32 v46, v32
ds_read_b128 a[128:131], v11 offset:16384
v_permlane32_swap_b32 v47, v33
v_mfma_f32_32x32x16_bf16 v[128:143], a[100:103], a[108:111], v[128:143]
v_permlane32_swap_b32 v48, v34
v_permlane32_swap_b32 v49, v35
ds_read_b128 a[132:135], v11 offset:20480
v_add_f32 v30, v30, v44
v_mfma_f32_32x32x16_bf16 v[96:111], a[96:99], a[112:115], v[96:111]
v_add_f32 v31, v31, v45
v_mfma_f32_32x32x16_bf16 v[144:159], a[100:103], a[112:115], v[144:159]
v_add_f32 v32, v32, v46
s_waitcnt lgkmcnt(4)
v_mfma_f32_32x32x16_bf16 v[64:79], a[116:119], a[124:127], v[64:79]
v_add_f32 v33, v33, v47
ds_read_b64_tr_b16 a[96:97], v8 offset:4096
v_add_f32 v34, v34, v48
ds_read_b64_tr_b16 a[98:99], v8 offset:4608
v_add_f32 v35, v35, v49
s_waitcnt lgkmcnt(4)
v_mfma_f32_32x32x16_bf16 v[112:127], a[120:123], a[124:127], v[112:127]
v_mov_b32 v44, v30
ds_read_b128 a[104:107], v12 offset:12288
v_mov_b32 v45, v31
ds_read_b64_tr_b16 a[100:101], v9 offset:4096
v_mov_b32 v46, v32
s_waitcnt lgkmcnt(5)
v_mfma_f32_32x32x16_bf16 v[80:95], a[116:119], a[128:131], v[80:95]
v_mov_b32 v47, v33
v_mov_b32 v48, v34
ds_read_b64_tr_b16 a[102:103], v9 offset:4608
v_mov_b32 v49, v35
ds_read_b128 a[108:111], v12 offset:16384
v_permlane16_swap_b32 v44, v30
v_mfma_f32_32x32x16_bf16 v[128:143], a[120:123], a[128:131], v[128:143]
v_permlane16_swap_b32 v45, v31
ds_read_b128 a[112:115], v12 offset:20480
v_permlane16_swap_b32 v46, v32
s_waitcnt lgkmcnt(7)
v_mfma_f32_32x32x16_bf16 v[96:111], a[116:119], a[132:135], v[96:111]
v_permlane16_swap_b32 v47, v33
v_mfma_f32_32x32x16_bf16 v[144:159], a[120:123], a[132:135], v[144:159]
v_permlane16_swap_b32 v48, v34
s_waitcnt lgkmcnt(4)
v_mfma_f32_32x32x16_bf16 v[64:79], a[96:99], a[104:107], v[64:79]
v_permlane16_swap_b32 v49, v35
ds_read_b64_tr_b16 a[116:117], v8 offset:6144
v_add_f32 v30, v30, v44
ds_read_b64_tr_b16 a[118:119], v8 offset:6656
v_add_f32 v31, v31, v45
v_add_f32 v32, v32, v46
s_waitcnt lgkmcnt(4)
v_mfma_f32_32x32x16_bf16 v[112:127], a[100:103], a[104:107], v[112:127]
v_add_f32 v33, v33, v47
ds_read_b128 a[124:127], v13 offset:12288
v_add_f32 v34, v34, v48
ds_read_b64_tr_b16 a[120:121], v9 offset:6144
v_add_f32 v35, v35, v49
s_waitcnt lgkmcnt(5)
v_mfma_f32_32x32x16_bf16 v[80:95], a[96:99], a[108:111], v[80:95]
ds_write_b32 v21, v30 offset:2048
ds_read_b64_tr_b16 a[122:123], v9 offset:6656
ds_write_b32 v21, v31 offset:2304
ds_read_b128 a[128:131], v13 offset:16384
ds_write_b32 v21, v32 offset:2560
v_mfma_f32_32x32x16_bf16 v[128:143], a[100:103], a[108:111], v[128:143]
ds_write_b32 v21, v33 offset:2816
ds_read_b128 a[132:135], v13 offset:20480
ds_write_b32 v21, v34 offset:3072
s_waitcnt lgkmcnt(12)
v_mfma_f32_32x32x16_bf16 v[96:111], a[96:99], a[112:115], v[96:111]
ds_write_b32 v21, v35 offset:3328
v_mfma_f32_32x32x16_bf16 v[144:159], a[100:103], a[112:115], v[144:159]
s_waitcnt lgkmcnt(0)
s_barrier
v_mfma_f32_32x32x16_bf16 v[64:79], a[116:119], a[124:127], v[64:79]
ds_read_b128 v[44:47], v22 offset:2048
s_waitcnt lgkmcnt(0)
v_add_f32 v44, v44, v45
v_add_f32 v46, v46, v47
v_add_f32 v44, v44, v46
v_rcp_f32 v24, v44
v_mfma_f32_32x32x16_bf16 v[112:127], a[120:123], a[124:127], v[112:127]
ds_read_b128 v[48:51], v22 offset:2304
s_waitcnt lgkmcnt(0)
v_add_f32 v48, v48, v49
v_add_f32 v50, v50, v51
v_add_f32 v48, v48, v50
v_rcp_f32 v25, v48
v_mfma_f32_32x32x16_bf16 v[80:95], a[116:119], a[128:131], v[80:95]
ds_read_b128 v[52:55], v22 offset:2560
s_waitcnt lgkmcnt(0)
v_add_f32 v52, v52, v53
v_add_f32 v54, v54, v55
v_add_f32 v52, v52, v54
v_rcp_f32 v26, v52
v_mfma_f32_32x32x16_bf16 v[128:143], a[120:123], a[128:131], v[128:143]
ds_read_b128 v[44:47], v22 offset:2816
s_waitcnt lgkmcnt(0)
v_add_f32 v44, v44, v45
v_add_f32 v46, v46, v47
v_add_f32 v44, v44, v46
v_rcp_f32 v27, v44
v_mfma_f32_32x32x16_bf16 v[96:111], a[116:119], a[132:135], v[96:111]
ds_read_b128 v[48:51], v22 offset:3072
s_waitcnt lgkmcnt(0)
v_add_f32 v48, v48, v49
v_add_f32 v50, v50, v51
v_add_f32 v48, v48, v50
v_rcp_f32 v28, v48
v_mfma_f32_32x32x16_bf16 v[144:159], a[120:123], a[132:135], v[144:159]
ds_read_b128 v[52:55], v22 offset:3328
s_waitcnt lgkmcnt(0)
v_add_f32 v52, v52, v53
v_add_f32 v54, v54, v55
v_add_f32 v52, v52, v54
v_rcp_f32 v29, v52
v_xor_b32 v56, 0, v19
v_cvt_pk_bf16_f32 v58, v64, v65
v_cvt_pk_bf16_f32 v59, v66, v67
ds_write_b64 v56, v[58:59] offset:0
v_cvt_pk_bf16_f32 v60, v80, v81
v_cvt_pk_bf16_f32 v61, v82, v83
ds_write_b64 v56, v[60:61] offset:16384
v_cvt_pk_bf16_f32 v62, v96, v97
v_cvt_pk_bf16_f32 v63, v98, v99
ds_write_b64 v56, v[62:63] offset:32768
s_add_u32 m0, s33, 65536
s_nop 0
buffer_load_dwordx4 v160, s[24:27], s37 offen  lds
v_xor_b32 v57, 16, v19
v_cvt_pk_bf16_f32 v58, v68, v69
v_cvt_pk_bf16_f32 v59, v70, v71
ds_write_b64 v57, v[58:59] offset:0
v_cvt_pk_bf16_f32 v60, v84, v85
v_cvt_pk_bf16_f32 v61, v86, v87
ds_write_b64 v57, v[60:61] offset:16384
v_cvt_pk_bf16_f32 v62, v100, v101
v_cvt_pk_bf16_f32 v63, v102, v103
ds_write_b64 v57, v[62:63] offset:32768
buffer_load_dwordx4 v161, s[24:27], s37 offen offset:1024  lds
v_xor_b32 v56, 32, v19
v_cvt_pk_bf16_f32 v58, v72, v73
v_cvt_pk_bf16_f32 v59, v74, v75
ds_write_b64 v56, v[58:59] offset:0
v_cvt_pk_bf16_f32 v60, v88, v89
v_cvt_pk_bf16_f32 v61, v90, v91
ds_write_b64 v56, v[60:61] offset:16384
buffer_load_dwordx4 v162, s[24:27], s37 offen offset:2048  lds
v_cvt_pk_bf16_f32 v62, v104, v105
v_cvt_pk_bf16_f32 v63, v106, v107
ds_write_b64 v56, v[62:63] offset:32768
v_xor_b32 v57, 48, v19
v_cvt_pk_bf16_f32 v58, v76, v77
v_cvt_pk_bf16_f32 v59, v78, v79
ds_write_b64 v57, v[58:59] offset:0
v_cvt_pk_bf16_f32 v60, v92, v93
v_cvt_pk_bf16_f32 v61, v94, v95
ds_write_b64 v57, v[60:61] offset:16384
buffer_load_dwordx4 v163, s[24:27], s37 offen offset:3072  lds
v_cvt_pk_bf16_f32 v62, v108, v109
v_cvt_pk_bf16_f32 v63, v110, v111
ds_write_b64 v57, v[62:63] offset:32768
v_xor_b32 v56, 64, v19
v_cvt_pk_bf16_f32 v58, v112, v113
v_cvt_pk_bf16_f32 v59, v114, v115
ds_write_b64 v56, v[58:59] offset:0
s_add_u32 m0, s33, 69632
s_nop 0
buffer_load_dwordx4 v164, s[24:27], s37 offen  lds
v_cvt_pk_bf16_f32 v60, v128, v129
v_cvt_pk_bf16_f32 v61, v130, v131
ds_write_b64 v56, v[60:61] offset:16384
v_cvt_pk_bf16_f32 v62, v144, v145
v_cvt_pk_bf16_f32 v63, v146, v147
ds_write_b64 v56, v[62:63] offset:32768
v_xor_b32 v57, 80, v19
v_cvt_pk_bf16_f32 v58, v116, v117
v_cvt_pk_bf16_f32 v59, v118, v119
ds_write_b64 v57, v[58:59] offset:0
buffer_load_dwordx4 v165, s[24:27], s37 offen offset:1024  lds
v_cvt_pk_bf16_f32 v60, v132, v133
v_cvt_pk_bf16_f32 v61, v134, v135
ds_write_b64 v57, v[60:61] offset:16384
v_cvt_pk_bf16_f32 v62, v148, v149
v_cvt_pk_bf16_f32 v63, v150, v151
ds_write_b64 v57, v[62:63] offset:32768
v_xor_b32 v56, 96, v19
buffer_load_dwordx4 v166, s[24:27], s37 offen offset:2048  lds
v_cvt_pk_bf16_f32 v58, v120, v121
v_cvt_pk_bf16_f32 v59, v122, v123
ds_write_b64 v56, v[58:59] offset:0
v_cvt_pk_bf16_f32 v60, v136, v137
v_cvt_pk_bf16_f32 v61, v138, v139
ds_write_b64 v56, v[60:61] offset:16384
v_cvt_pk_bf16_f32 v62, v152, v153
v_cvt_pk_bf16_f32 v63, v154, v155
ds_write_b64 v56, v[62:63] offset:32768
v_xor_b32 v57, 112, v19
buffer_load_dwordx4 v167, s[24:27], s37 offen offset:3072  lds
v_cvt_pk_bf16_f32 v58, v124, v125
v_cvt_pk_bf16_f32 v59, v126, v127
ds_write_b64 v57, v[58:59] offset:0
v_cvt_pk_bf16_f32 v60, v140, v141
v_cvt_pk_bf16_f32 v61, v142, v143
ds_write_b64 v57, v[60:61] offset:16384
v_cvt_pk_bf16_f32 v62, v156, v157
v_cvt_pk_bf16_f32 v63, v158, v159
ds_write_b64 v57, v[62:63] offset:32768
v_readfirstlane_b32 s94, v40
s_nop 3
s_cmp_lg_u32 s94, 0
s_cbranch_scc1 L_havenonce
s_mov_b32 s63, 0x100000
L_pollnonce:
s_sub_u32 s63, s63, 1
s_cbranch_scc1 L_havenonce
v_mov_b32 v44, 0
global_load_dword v40, v44, s[96:97] sc1
s_waitcnt vmcnt(0)
v_readfirstlane_b32 s94, v40
s_nop 3
s_cmp_eq_u32 s94, 0
s_cbranch_scc1 L_pollnonce
L_havenonce:
s_lshl_b32 s4, s83, 8
s_add_u32 s4, s4, 33554432
s_add_u32 s68, s58, s4
s_addc_u32 s69, s59, 0
s_waitcnt vmcnt(8)
s_waitcnt lgkmcnt(0)
s_barrier
v_add_u32 v38, 0x10000, v20
ds_read_b64_tr_b16 a[192:193], v20 offset:32768
ds_read_b64_tr_b16 a[194:195], v20 offset:33280
ds_read_b128 a[0:3], v14 offset:0
ds_read_b64_tr_b16 a[196:197], v20 offset:36864
ds_read_b64_tr_b16 a[198:199], v20 offset:37376
ds_read_b128 a[24:27], v15 offset:0
ds_read_b64_tr_b16 a[200:201], v20 offset:40960
ds_read_b64_tr_b16 a[202:203], v20 offset:41472
ds_read_b128 a[48:51], v16 offset:0
ds_read_b64_tr_b16 a[204:205], v20 offset:45056
ds_read_b64_tr_b16 a[206:207], v20 offset:45568
ds_read_b128 a[72:75], v17 offset:0
ds_read_b64_tr_b16 a[208:209], v20 offset:49152
ds_read_b64_tr_b16 a[210:211], v20 offset:49664
ds_read_b128 a[96:99], v14 offset:256
ds_read_b64_tr_b16 a[212:213], v20 offset:53248
ds_read_b64_tr_b16 a[214:215], v20 offset:53760
ds_read_b128 a[120:123], v15 offset:256
ds_read_b64_tr_b16 a[216:217], v20 offset:57344
ds_read_b64_tr_b16 a[218:219], v20 offset:57856
ds_read_b128 a[144:147], v16 offset:256
ds_read_b64_tr_b16 a[220:221], v20 offset:61440
ds_read_b64_tr_b16 a[222:223], v20 offset:61952
ds_read_b128 a[168:171], v17 offset:256
s_mov_b32 m0, s33
s_nop 0
buffer_load_dwordx4 v160, s[24:27], s38 offen  lds
buffer_load_dwordx4 v161, s[24:27], s38 offen offset:1024  lds
buffer_load_dwordx4 v162, s[24:27], s38 offen offset:2048  lds
buffer_load_dwordx4 v163, s[24:27], s38 offen offset:3072  lds
s_add_u32 m0, s33, 4096
s_nop 0
buffer_load_dwordx4 v164, s[24:27], s38 offen  lds
buffer_load_dwordx4 v165, s[24:27], s38 offen offset:1024  lds
buffer_load_dwordx4 v166, s[24:27], s38 offen offset:2048  lds
buffer_load_dwordx4 v167, s[24:27], s38 offen offset:3072  lds
s_waitcnt lgkmcnt(15)
v_mfma_f32_16x16x32_bf16 v[64:67], a[192:195], a[0:3], 0
ds_read_b128 a[4:7], v14 offset:8192
v_mfma_f32_16x16x32_bf16 v[64:67], a[196:199], a[24:27], v[64:67]
ds_read_b128 a[28:31], v15 offset:8192
v_mfma_f32_16x16x32_bf16 v[64:67], a[200:203], a[48:51], v[64:67]
ds_read_b128 a[52:55], v16 offset:8192
s_waitcnt lgkmcnt(15)
v_mfma_f32_16x16x32_bf16 v[64:67], a[204:207], a[72:75], v[64:67]
ds_read_b128 a[76:79], v17 offset:8192
s_waitcnt lgkmcnt(13)
v_mfma_f32_16x16x32_bf16 v[64:67], a[208:211], a[96:99], v[64:67]
ds_read_b128 a[100:103], v14 offset:8448
s_waitcnt lgkmcnt(11)
v_mfma_f32_16x16x32_bf16 v[64:67], a[212:215], a[120:123], v[64:67]
ds_read_b128 a[124:127], v15 offset:8448
s_waitcnt lgkmcnt(9)
v_mfma_f32_16x16x32_bf16 v[64:67], a[216:219], a[144:147], v[64:67]
ds_read_b128 a[148:151], v16 offset:8448
s_waitcnt lgkmcnt(7)
v_mfma_f32_16x16x32_bf16 v[64:67], a[220:223], a[168:171], v[64:67]
ds_read_b128 a[172:175], v17 offset:8448
s_waitcnt lgkmcnt(7)
v_mfma_f32_16x16x32_bf16 v[68:71], a[192:195], a[4:7], 0
ds_read_b128 a[8:11], v14 offset:16384
s_waitcnt lgkmcnt(7)
v_mfma_f32_16x16x32_bf16 v[68:71], a[196:199], a[28:31], v[68:71]
ds_read_b128 a[32:35], v15 offset:16384
s_waitcnt lgkmcnt(7)
v_mfma_f32_16x16x32_bf16 v[68:71], a[200:203], a[52:55], v[68:71]
ds_read_b128 a[56:59], v16 offset:16384
s_waitcnt lgkmcnt(7)
v_mfma_f32_16x16x32_bf16 v[68:71], a[204:207], a[76:79], v[68:71]
ds_read_b128 a[80:83], v17 offset:16384
s_waitcnt lgkmcnt(7)
v_mfma_f32_16x16x32_bf16 v[68:71], a[208:211], a[100:103], v[68:71]
ds_read_b128 a[104:107], v14 offset:16640
s_waitcnt lgkmcnt(7)
v_mfma_f32_16x16x32_bf16 v[68:71], a[212:215], a[124:127], v[68:71]
ds_read_b128 a[128:131], v15 offset:16640
s_waitcnt lgkmcnt(7)
v_mfma_f32_16x16x32_bf16 v[68:71], a[216:219], a[148:151], v[68:71]
ds_read_b128 a[152:155], v16 offset:16640
s_waitcnt lgkmcnt(7)
v_mfma_f32_16x16x32_bf16 v[68:71], a[220:223], a[172:175], v[68:71]
ds_read_b128 a[176:179], v17 offset:16640
s_waitcnt vmcnt(8)
s_barrier
s_waitcnt lgkmcnt(7)
v_mfma_f32_16x16x32_bf16 v[72:75], a[192:195], a[8:11], 0
ds_read_b128 a[12:15], v14 offset:24576
ds_read_b64_tr_b16 a[224:225], v38 offset:0
ds_read_b128 a[36:39], v15 offset:24576
s_waitcnt lgkmcnt(9)
v_mfma_f32_16x16x32_bf16 v[72:75], a[196:199], a[32:35], v[72:75]
ds_read_b128 a[60:63], v16 offset:24576
ds_read_b128 a[84:87], v17 offset:24576
s_waitcnt lgkmcnt(10)
v_mfma_f32_16x16x32_bf16 v[72:75], a[200:203], a[56:59], v[72:75]
ds_read_b128 a[108:111], v14 offset:24832
ds_read_b64_tr_b16 a[226:227], v38 offset:512
s_waitcnt lgkmcnt(11)
v_mfma_f32_16x16x32_bf16 v[72:75], a[204:207], a[80:83], v[72:75]
ds_read_b128 a[132:135], v15 offset:24832
ds_read_b128 a[156:159], v16 offset:24832
s_add_u32 m0, s33, 32768
s_nop 0
buffer_load_dwordx4 v160, s[24:27], s39 offen  lds
s_waitcnt lgkmcnt(12)
v_mfma_f32_16x16x32_bf16 v[72:75], a[208:211], a[104:107], v[72:75]
ds_read_b128 a[180:183], v17 offset:24832
v_mul_f32 v64, v24, v64
ds_read_b64_tr_b16 a[228:229], v38 offset:4096
s_waitcnt lgkmcnt(13)
v_mfma_f32_16x16x32_bf16 v[72:75], a[212:215], a[128:131], v[72:75]
v_mul_f32 v65, v24, v65
v_mul_f32 v66, v24, v66
s_waitcnt lgkmcnt(12)
v_mfma_f32_16x16x32_bf16 v[72:75], a[216:219], a[152:155], v[72:75]
buffer_load_dwordx4 v161, s[24:27], s39 offen offset:1024  lds
v_mul_f32 v67, v24, v67
v_cvt_pk_bf16_f32 v52, v64, v65
s_waitcnt lgkmcnt(11)
v_mfma_f32_16x16x32_bf16 v[72:75], a[220:223], a[176:179], v[72:75]
ds_read_b64_tr_b16 a[230:231], v38 offset:4608
v_cvt_pk_bf16_f32 v53, v66, v67
s_waitcnt lgkmcnt(11)
v_mfma_f32_16x16x32_bf16 v[76:79], a[192:195], a[12:15], 0
ds_read_b128 a[16:19], v14 offset:32768
ds_read_b64_tr_b16 a[232:233], v38 offset:8192
ds_read_b128 a[40:43], v15 offset:32768
s_waitcnt lgkmcnt(12)
v_mfma_f32_16x16x32_bf16 v[76:79], a[196:199], a[36:39], v[76:79]
ds_read_b128 a[64:67], v16 offset:32768
buffer_load_dwordx4 v162, s[24:27], s39 offen offset:2048  lds
ds_read_b128 a[88:91], v17 offset:32768
s_waitcnt lgkmcnt(13)
v_mfma_f32_16x16x32_bf16 v[76:79], a[200:203], a[60:63], v[76:79]
ds_read_b128 a[112:115], v14 offset:33024
ds_read_b128 a[136:139], v15 offset:33024
s_waitcnt lgkmcnt(14)
v_mfma_f32_16x16x32_bf16 v[76:79], a[204:207], a[84:87], v[76:79]
ds_read_b64_tr_b16 a[234:235], v38 offset:8704
ds_read_b128 a[160:163], v16 offset:33024
ds_read_b128 a[184:187], v17 offset:33024
s_waitcnt lgkmcnt(15)
v_mfma_f32_16x16x32_bf16 v[76:79], a[208:211], a[108:111], v[76:79]
ds_read_b64_tr_b16 a[236:237], v38 offset:12288
v_mul_f32 v68, v25, v68
v_mul_f32 v69, v25, v69
s_waitcnt lgkmcnt(15)
v_mfma_f32_16x16x32_bf16 v[76:79], a[212:215], a[132:135], v[76:79]
v_mul_f32 v70, v25, v70
buffer_load_dwordx4 v163, s[24:27], s39 offen offset:3072  lds
s_waitcnt lgkmcnt(14)
v_mfma_f32_16x16x32_bf16 v[76:79], a[216:219], a[156:159], v[76:79]
v_mul_f32 v71, v25, v71
v_cvt_pk_bf16_f32 v54, v68, v69
ds_read_b64_tr_b16 a[238:239], v38 offset:12800
s_waitcnt lgkmcnt(14)
v_mfma_f32_16x16x32_bf16 v[76:79], a[220:223], a[180:183], v[76:79]
v_cvt_pk_bf16_f32 v55, v70, v71
buffer_store_dwordx4 v[52:55], v23, s[28:31], s44 offen offset:0 sc1
s_waitcnt lgkmcnt(11)
v_mfma_f32_16x16x32_bf16 v[80:83], a[192:195], a[16:19], 0
ds_read_b128 a[20:23], v14 offset:40960
ds_read_b64_tr_b16 a[240:241], v38 offset:16384
ds_read_b128 a[44:47], v15 offset:40960
s_waitcnt lgkmcnt(12)
v_mfma_f32_16x16x32_bf16 v[80:83], a[196:199], a[40:43], v[80:83]
ds_read_b128 a[68:71], v16 offset:40960
s_add_u32 m0, s33, 36864
s_nop 0
buffer_load_dwordx4 v164, s[24:27], s39 offen  lds
s_waitcnt lgkmcnt(12)
v_mfma_f32_16x16x32_bf16 v[80:83], a[200:203], a[64:67], v[80:83]
ds_read_b128 a[92:95], v17 offset:40960
ds_read_b128 a[116:119], v14 offset:41216
ds_read_b64_tr_b16 a[242:243], v38 offset:16896
s_waitcnt lgkmcnt(14)
v_mfma_f32_16x16x32_bf16 v[80:83], a[204:207], a[88:91], v[80:83]
ds_read_b128 a[140:143], v15 offset:41216
ds_read_b128 a[164:167], v16 offset:41216
s_waitcnt lgkmcnt(15)
v_mfma_f32_16x16x32_bf16 v[80:83], a[208:211], a[112:115], v[80:83]
ds_read_b128 a[188:191], v17 offset:41216
ds_read_b64_tr_b16 a[244:245], v38 offset:20480
v_mul_f32 v72, v26, v72
s_waitcnt lgkmcnt(15)
v_mfma_f32_16x16x32_bf16 v[80:83], a[212:215], a[136:139], v[80:83]
v_mul_f32 v73, v26, v73
buffer_load_dwordx4 v165, s[24:27], s39 offen offset:1024  lds
s_waitcnt lgkmcnt(14)
v_mfma_f32_16x16x32_bf16 v[80:83], a[216:219], a[160:163], v[80:83]
v_mul_f32 v74, v26, v74
v_mul_f32 v75, v26, v75
ds_read_b64_tr_b16 a[246:247], v38 offset:20992
s_waitcnt lgkmcnt(14)
v_mfma_f32_16x16x32_bf16 v[80:83], a[220:223], a[184:187], v[80:83]
v_cvt_pk_bf16_f32 v56, v72, v73
v_cvt_pk_bf16_f32 v57, v74, v75
s_waitcnt lgkmcnt(11)
v_mfma_f32_16x16x32_bf16 v[84:87], a[192:195], a[20:23], 0
v_mul_f32 v76, v27, v76
ds_read_b64_tr_b16 a[248:249], v38 offset:24576
s_waitcnt lgkmcnt(10)
v_mfma_f32_16x16x32_bf16 v[84:87], a[196:199], a[44:47], v[84:87]
v_mul_f32 v77, v27, v77
buffer_load_dwordx4 v166, s[24:27], s39 offen offset:2048  lds
s_waitcnt lgkmcnt(9)
v_mfma_f32_16x16x32_bf16 v[84:87], a[200:203], a[68:71], v[84:87]
v_mul_f32 v78, v27, v78
s_waitcnt lgkmcnt(8)
v_mfma_f32_16x16x32_bf16 v[84:87], a[204:207], a[92:95], v[84:87]
ds_read_b64_tr_b16 a[250:251], v38 offset:25088
v_mul_f32 v79, v27, v79
s_waitcnt lgkmcnt(8)
v_mfma_f32_16x16x32_bf16 v[84:87], a[208:211], a[116:119], v[84:87]
ds_read_b64_tr_b16 a[252:253], v38 offset:28672
v_cvt_pk_bf16_f32 v58, v76, v77
s_waitcnt lgkmcnt(7)
v_mfma_f32_16x16x32_bf16 v[84:87], a[212:215], a[140:143], v[84:87]
buffer_load_dwordx4 v167, s[24:27], s39 offen offset:3072  lds
s_waitcnt lgkmcnt(6)
v_mfma_f32_16x16x32_bf16 v[84:87], a[216:219], a[164:167], v[84:87]
v_cvt_pk_bf16_f32 v59, v78, v79
ds_read_b64_tr_b16 a[254:255], v38 offset:29184
s_waitcnt lgkmcnt(6)
v_mfma_f32_16x16x32_bf16 v[84:87], a[220:223], a[188:191], v[84:87]
buffer_store_dwordx4 v[56:59], v23, s[28:31], s44 offen offset:1024 sc1
v_mfma_f32_16x16x32_bf16 v[64:67], a[224:227], a[0:3], 0
v_mul_f32 v80, v28, v80
v_mfma_f32_16x16x32_bf16 v[64:67], a[228:231], a[24:27], v[64:67]
v_mul_f32 v81, v28, v81
v_mfma_f32_16x16x32_bf16 v[64:67], a[232:235], a[48:51], v[64:67]
v_mul_f32 v82, v28, v82
v_mfma_f32_16x16x32_bf16 v[64:67], a[236:239], a[72:75], v[64:67]
v_mfma_f32_16x16x32_bf16 v[64:67], a[240:243], a[96:99], v[64:67]
v_mul_f32 v83, v28, v83
s_waitcnt lgkmcnt(4)
v_mfma_f32_16x16x32_bf16 v[64:67], a[244:247], a[120:123], v[64:67]
v_cvt_pk_bf16_f32 v52, v80, v81
s_waitcnt lgkmcnt(2)
v_mfma_f32_16x16x32_bf16 v[64:67], a[248:251], a[144:147], v[64:67]
v_cvt_pk_bf16_f32 v53, v82, v83
s_waitcnt lgkmcnt(0)
v_mfma_f32_16x16x32_bf16 v[64:67], a[252:255], a[168:171], v[64:67]
v_mfma_f32_16x16x32_bf16 v[68:71], a[224:227], a[4:7], 0
v_mul_f32 v84, v29, v84
v_mfma_f32_16x16x32_bf16 v[68:71], a[228:231], a[28:31], v[68:71]
v_mul_f32 v85, v29, v85
v_mfma_f32_16x16x32_bf16 v[68:71], a[232:235], a[52:55], v[68:71]
v_mul_f32 v86, v29, v86
v_mfma_f32_16x16x32_bf16 v[68:71], a[236:239], a[76:79], v[68:71]
v_mul_f32 v87, v29, v87
v_mfma_f32_16x16x32_bf16 v[68:71], a[240:243], a[100:103], v[68:71]
v_cvt_pk_bf16_f32 v54, v84, v85
v_mfma_f32_16x16x32_bf16 v[68:71], a[244:247], a[124:127], v[68:71]
v_cvt_pk_bf16_f32 v55, v86, v87
v_mfma_f32_16x16x32_bf16 v[68:71], a[248:251], a[148:151], v[68:71]
buffer_store_dwordx4 v[52:55], v23, s[28:31], s44 offen offset:2048 sc1
v_mfma_f32_16x16x32_bf16 v[68:71], a[252:255], a[172:175], v[68:71]
s_waitcnt vmcnt(8)
s_barrier
v_mfma_f32_16x16x32_bf16 v[72:75], a[224:227], a[8:11], 0
ds_read_b64_tr_b16 a[192:193], v20 offset:0
v_mul_f32 v64, v24, v64
v_mfma_f32_16x16x32_bf16 v[72:75], a[228:231], a[32:35], v[72:75]
v_mul_f32 v65, v24, v65
v_mfma_f32_16x16x32_bf16 v[72:75], a[232:235], a[56:59], v[72:75]
ds_read_b64_tr_b16 a[194:195], v20 offset:512
v_mfma_f32_16x16x32_bf16 v[72:75], a[236:239], a[80:83], v[72:75]
v_mul_f32 v66, v24, v66
s_add_u32 m0, s33, 65536
s_nop 0
buffer_load_dwordx4 v160, s[24:27], s40 offen  lds
v_mfma_f32_16x16x32_bf16 v[72:75], a[240:243], a[104:107], v[72:75]
v_mul_f32 v67, v24, v67
ds_read_b64_tr_b16 a[196:197], v20 offset:4096
v_mfma_f32_16x16x32_bf16 v[72:75], a[244:247], a[128:131], v[72:75]
v_cvt_pk_bf16_f32 v52, v64, v65
v_mfma_f32_16x16x32_bf16 v[72:75], a[248:251], a[152:155], v[72:75]
buffer_load_dwordx4 v161, s[24:27], s40 offen offset:1024  lds
v_cvt_pk_bf16_f32 v53, v66, v67
v_mfma_f32_16x16x32_bf16 v[72:75], a[252:255], a[176:179], v[72:75]
ds_read_b64_tr_b16 a[198:199], v20 offset:4608
v_mfma_f32_16x16x32_bf16 v[76:79], a[224:227], a[12:15], 0
v_mul_f32 v68, v25, v68
ds_read_b64_tr_b16 a[200:201], v20 offset:8192
v_mfma_f32_16x16x32_bf16 v[76:79], a[228:231], a[36:39], v[76:79]
v_mul_f32 v69, v25, v69
buffer_load_dwordx4 v162, s[24:27], s40 offen offset:2048  lds
v_mfma_f32_16x16x32_bf16 v[76:79], a[232:235], a[60:63], v[76:79]
v_mul_f32 v70, v25, v70
v_mfma_f32_16x16x32_bf16 v[76:79], a[236:239], a[84:87], v[76:79]
ds_read_b64_tr_b16 a[202:203], v20 offset:8704
v_mul_f32 v71, v25, v71
v_mfma_f32_16x16x32_bf16 v[76:79], a[240:243], a[108:111], v[76:79]
ds_read_b64_tr_b16 a[204:205], v20 offset:12288
v_cvt_pk_bf16_f32 v54, v68, v69
v_mfma_f32_16x16x32_bf16 v[76:79], a[244:247], a[132:135], v[76:79]
buffer_load_dwordx4 v163, s[24:27], s40 offen offset:3072  lds
v_mfma_f32_16x16x32_bf16 v[76:79], a[248:251], a[156:159], v[76:79]
v_cvt_pk_bf16_f32 v55, v70, v71
ds_read_b64_tr_b16 a[206:207], v20 offset:12800
v_mfma_f32_16x16x32_bf16 v[76:79], a[252:255], a[180:183], v[76:79]
buffer_store_dwordx4 v[52:55], v23, s[28:31], s45 offen offset:0 sc1
v_mfma_f32_16x16x32_bf16 v[80:83], a[224:227], a[16:19], 0
v_mul_f32 v72, v26, v72
ds_read_b64_tr_b16 a[208:209], v20 offset:16384
v_mfma_f32_16x16x32_bf16 v[80:83], a[228:231], a[40:43], v[80:83]
v_mul_f32 v73, v26, v73
v_mfma_f32_16x16x32_bf16 v[80:83], a[232:235], a[64:67], v[80:83]
s_add_u32 m0, s33, 69632
s_nop 0
buffer_load_dwordx4 v164, s[24:27], s40 offen  lds
v_mul_f32 v74, v26, v74
v_mfma_f32_16x16x32_bf16 v[80:83], a[236:239], a[88:91], v[80:83]
ds_read_b64_tr_b16 a[210:211], v20 offset:16896
v_mfma_f32_16x16x32_bf16 v[80:83], a[240:243], a[112:115], v[80:83]
v_mul_f32 v75, v26, v75
ds_read_b64_tr_b16 a[212:213], v20 offset:20480
v_mfma_f32_16x16x32_bf16 v[80:83], a[244:247], a[136:139], v[80:83]
v_cvt_pk_bf16_f32 v56, v72, v73
v_mfma_f32_16x16x32_bf16 v[80:83], a[248:251], a[160:163], v[80:83]
buffer_load_dwordx4 v165, s[24:27], s40 offen offset:1024  lds
v_cvt_pk_bf16_f32 v57, v74, v75
v_mfma_f32_16x16x32_bf16 v[80:83], a[252:255], a[184:187], v[80:83]
ds_read_b64_tr_b16 a[214:215], v20 offset:20992
v_mfma_f32_16x16x32_bf16 v[84:87], a[224:227], a[20:23], 0
v_mul_f32 v76, v27, v76
ds_read_b64_tr_b16 a[216:217], v20 offset:24576
v_mfma_f32_16x16x32_bf16 v[84:87], a[228:231], a[44:47], v[84:87]
v_mul_f32 v77, v27, v77
buffer_load_dwordx4 v166, s[24:27], s40 offen offset:2048  lds
v_mfma_f32_16x16x32_bf16 v[84:87], a[232:235], a[68:71], v[84:87]
v_mul_f32 v78, v27, v78
v_mfma_f32_16x16x32_bf16 v[84:87], a[236:239], a[92:95], v[84:87]
ds_read_b64_tr_b16 a[218:219], v20 offset:25088
v_mul_f32 v79, v27, v79
v_mfma_f32_16x16x32_bf16 v[84:87], a[240:243], a[116:119], v[84:87]
ds_read_b64_tr_b16 a[220:221], v20 offset:28672
v_cvt_pk_bf16_f32 v58, v76, v77
v_mfma_f32_16x16x32_bf16 v[84:87], a[244:247], a[140:143], v[84:87]
buffer_load_dwordx4 v167, s[24:27], s40 offen offset:3072  lds
v_mfma_f32_16x16x32_bf16 v[84:87], a[248:251], a[164:167], v[84:87]
v_cvt_pk_bf16_f32 v59, v78, v79
ds_read_b64_tr_b16 a[222:223], v20 offset:29184
v_mfma_f32_16x16x32_bf16 v[84:87], a[252:255], a[188:191], v[84:87]
buffer_store_dwordx4 v[56:59], v23, s[28:31], s45 offen offset:1024 sc1
s_waitcnt lgkmcnt(14)
v_mfma_f32_16x16x32_bf16 v[64:67], a[192:195], a[0:3], 0
v_mul_f32 v80, v28, v80
s_waitcnt lgkmcnt(12)
v_mfma_f32_16x16x32_bf16 v[64:67], a[196:199], a[24:27], v[64:67]
v_mul_f32 v81, v28, v81
s_waitcnt lgkmcnt(10)
v_mfma_f32_16x16x32_bf16 v[64:67], a[200:203], a[48:51], v[64:67]
v_mul_f32 v82, v28, v82
s_waitcnt lgkmcnt(8)
v_mfma_f32_16x16x32_bf16 v[64:67], a[204:207], a[72:75], v[64:67]
s_waitcnt lgkmcnt(6)
v_mfma_f32_16x16x32_bf16 v[64:67], a[208:211], a[96:99], v[64:67]
v_mul_f32 v83, v28, v83
s_waitcnt lgkmcnt(4)
v_mfma_f32_16x16x32_bf16 v[64:67], a[212:215], a[120:123], v[64:67]
v_cvt_pk_bf16_f32 v52, v80, v81
s_waitcnt lgkmcnt(2)
v_mfma_f32_16x16x32_bf16 v[64:67], a[216:219], a[144:147], v[64:67]
v_cvt_pk_bf16_f32 v53, v82, v83
s_waitcnt lgkmcnt(0)
v_mfma_f32_16x16x32_bf16 v[64:67], a[220:223], a[168:171], v[64:67]
v_mfma_f32_16x16x32_bf16 v[68:71], a[192:195], a[4:7], 0
v_mul_f32 v84, v29, v84
v_mfma_f32_16x16x32_bf16 v[68:71], a[196:199], a[28:31], v[68:71]
v_mul_f32 v85, v29, v85
v_mfma_f32_16x16x32_bf16 v[68:71], a[200:203], a[52:55], v[68:71]
v_mul_f32 v86, v29, v86
v_mfma_f32_16x16x32_bf16 v[68:71], a[204:207], a[76:79], v[68:71]
v_mul_f32 v87, v29, v87
v_mfma_f32_16x16x32_bf16 v[68:71], a[208:211], a[100:103], v[68:71]
v_cvt_pk_bf16_f32 v54, v84, v85
v_mfma_f32_16x16x32_bf16 v[68:71], a[212:215], a[124:127], v[68:71]
v_cvt_pk_bf16_f32 v55, v86, v87
v_mfma_f32_16x16x32_bf16 v[68:71], a[216:219], a[148:151], v[68:71]
buffer_store_dwordx4 v[52:55], v23, s[28:31], s45 offen offset:2048 sc1
v_mfma_f32_16x16x32_bf16 v[68:71], a[220:223], a[172:175], v[68:71]
s_waitcnt vmcnt(8)
s_barrier
v_mfma_f32_16x16x32_bf16 v[72:75], a[192:195], a[8:11], 0
ds_read_b64_tr_b16 a[224:225], v20 offset:32768
v_mul_f32 v64, v24, v64
v_mfma_f32_16x16x32_bf16 v[72:75], a[196:199], a[32:35], v[72:75]
v_mul_f32 v65, v24, v65
v_mfma_f32_16x16x32_bf16 v[72:75], a[200:203], a[56:59], v[72:75]
ds_read_b64_tr_b16 a[226:227], v20 offset:33280
v_mfma_f32_16x16x32_bf16 v[72:75], a[204:207], a[80:83], v[72:75]
v_mul_f32 v66, v24, v66
s_mov_b32 m0, s33
s_nop 0
buffer_load_dwordx4 v160, s[24:27], s41 offen  lds
v_mfma_f32_16x16x32_bf16 v[72:75], a[208:211], a[104:107], v[72:75]
v_mul_f32 v67, v24, v67
ds_read_b64_tr_b16 a[228:229], v20 offset:36864
v_mfma_f32_16x16x32_bf16 v[72:75], a[212:215], a[128:131], v[72:75]
v_cvt_pk_bf16_f32 v52, v64, v65
v_mfma_f32_16x16x32_bf16 v[72:75], a[216:219], a[152:155], v[72:75]
buffer_load_dwordx4 v161, s[24:27], s41 offen offset:1024  lds
v_cvt_pk_bf16_f32 v53, v66, v67
v_mfma_f32_16x16x32_bf16 v[72:75], a[220:223], a[176:179], v[72:75]
ds_read_b64_tr_b16 a[230:231], v20 offset:37376
v_mfma_f32_16x16x32_bf16 v[76:79], a[192:195], a[12:15], 0
v_mul_f32 v68, v25, v68
ds_read_b64_tr_b16 a[232:233], v20 offset:40960
v_mfma_f32_16x16x32_bf16 v[76:79], a[196:199], a[36:39], v[76:79]
v_mul_f32 v69, v25, v69
buffer_load_dwordx4 v162, s[24:27], s41 offen offset:2048  lds
v_mfma_f32_16x16x32_bf16 v[76:79], a[200:203], a[60:63], v[76:79]
v_mul_f32 v70, v25, v70
v_mfma_f32_16x16x32_bf16 v[76:79], a[204:207], a[84:87], v[76:79]
ds_read_b64_tr_b16 a[234:235], v20 offset:41472
v_mul_f32 v71, v25, v71
v_mfma_f32_16x16x32_bf16 v[76:79], a[208:211], a[108:111], v[76:79]
ds_read_b64_tr_b16 a[236:237], v20 offset:45056
v_cvt_pk_bf16_f32 v54, v68, v69
v_mfma_f32_16x16x32_bf16 v[76:79], a[212:215], a[132:135], v[76:79]
buffer_load_dwordx4 v163, s[24:27], s41 offen offset:3072  lds
v_mfma_f32_16x16x32_bf16 v[76:79], a[216:219], a[156:159], v[76:79]
v_cvt_pk_bf16_f32 v55, v70, v71
ds_read_b64_tr_b16 a[238:239], v20 offset:45568
v_mfma_f32_16x16x32_bf16 v[76:79], a[220:223], a[180:183], v[76:79]
buffer_store_dwordx4 v[52:55], v23, s[28:31], s46 offen offset:0 sc1
v_mfma_f32_16x16x32_bf16 v[80:83], a[192:195], a[16:19], 0
v_mul_f32 v72, v26, v72
ds_read_b64_tr_b16 a[240:241], v20 offset:49152
v_mfma_f32_16x16x32_bf16 v[80:83], a[196:199], a[40:43], v[80:83]
v_mul_f32 v73, v26, v73
v_mfma_f32_16x16x32_bf16 v[80:83], a[200:203], a[64:67], v[80:83]
s_add_u32 m0, s33, 4096
s_nop 0
buffer_load_dwordx4 v164, s[24:27], s41 offen  lds
v_mul_f32 v74, v26, v74
v_mfma_f32_16x16x32_bf16 v[80:83], a[204:207], a[88:91], v[80:83]
ds_read_b64_tr_b16 a[242:243], v20 offset:49664
v_mfma_f32_16x16x32_bf16 v[80:83], a[208:211], a[112:115], v[80:83]
v_mul_f32 v75, v26, v75
ds_read_b64_tr_b16 a[244:245], v20 offset:53248
v_mfma_f32_16x16x32_bf16 v[80:83], a[212:215], a[136:139], v[80:83]
v_cvt_pk_bf16_f32 v56, v72, v73
v_mfma_f32_16x16x32_bf16 v[80:83], a[216:219], a[160:163], v[80:83]
buffer_load_dwordx4 v165, s[24:27], s41 offen offset:1024  lds
v_cvt_pk_bf16_f32 v57, v74, v75
v_mfma_f32_16x16x32_bf16 v[80:83], a[220:223], a[184:187], v[80:83]
ds_read_b64_tr_b16 a[246:247], v20 offset:53760
v_mfma_f32_16x16x32_bf16 v[84:87], a[192:195], a[20:23], 0
v_mul_f32 v76, v27, v76
ds_read_b64_tr_b16 a[248:249], v20 offset:57344
v_mfma_f32_16x16x32_bf16 v[84:87], a[196:199], a[44:47], v[84:87]
v_mul_f32 v77, v27, v77
buffer_load_dwordx4 v166, s[24:27], s41 offen offset:2048  lds
v_mfma_f32_16x16x32_bf16 v[84:87], a[200:203], a[68:71], v[84:87]
v_mul_f32 v78, v27, v78
v_mfma_f32_16x16x32_bf16 v[84:87], a[204:207], a[92:95], v[84:87]
ds_read_b64_tr_b16 a[250:251], v20 offset:57856
v_mul_f32 v79, v27, v79
v_mfma_f32_16x16x32_bf16 v[84:87], a[208:211], a[116:119], v[84:87]
ds_read_b64_tr_b16 a[252:253], v20 offset:61440
v_cvt_pk_bf16_f32 v58, v76, v77
v_mfma_f32_16x16x32_bf16 v[84:87], a[212:215], a[140:143], v[84:87]
buffer_load_dwordx4 v167, s[24:27], s41 offen offset:3072  lds
v_mfma_f32_16x16x32_bf16 v[84:87], a[216:219], a[164:167], v[84:87]
v_cvt_pk_bf16_f32 v59, v78, v79
ds_read_b64_tr_b16 a[254:255], v20 offset:61952
v_mfma_f32_16x16x32_bf16 v[84:87], a[220:223], a[188:191], v[84:87]
buffer_store_dwordx4 v[56:59], v23, s[28:31], s46 offen offset:1024 sc1
s_waitcnt lgkmcnt(14)
v_mfma_f32_16x16x32_bf16 v[64:67], a[224:227], a[0:3], 0
v_mul_f32 v80, v28, v80
s_waitcnt lgkmcnt(12)
v_mfma_f32_16x16x32_bf16 v[64:67], a[228:231], a[24:27], v[64:67]
v_mul_f32 v81, v28, v81
s_waitcnt lgkmcnt(10)
v_mfma_f32_16x16x32_bf16 v[64:67], a[232:235], a[48:51], v[64:67]
v_mul_f32 v82, v28, v82
s_waitcnt lgkmcnt(8)
v_mfma_f32_16x16x32_bf16 v[64:67], a[236:239], a[72:75], v[64:67]
s_waitcnt lgkmcnt(6)
v_mfma_f32_16x16x32_bf16 v[64:67], a[240:243], a[96:99], v[64:67]
v_mul_f32 v83, v28, v83
s_waitcnt lgkmcnt(4)
v_mfma_f32_16x16x32_bf16 v[64:67], a[244:247], a[120:123], v[64:67]
v_cvt_pk_bf16_f32 v52, v80, v81
s_waitcnt lgkmcnt(2)
v_mfma_f32_16x16x32_bf16 v[64:67], a[248:251], a[144:147], v[64:67]
v_cvt_pk_bf16_f32 v53, v82, v83
s_waitcnt lgkmcnt(0)
v_mfma_f32_16x16x32_bf16 v[64:67], a[252:255], a[168:171], v[64:67]
v_mfma_f32_16x16x32_bf16 v[68:71], a[224:227], a[4:7], 0
v_mul_f32 v84, v29, v84
v_mfma_f32_16x16x32_bf16 v[68:71], a[228:231], a[28:31], v[68:71]
v_mul_f32 v85, v29, v85
v_mfma_f32_16x16x32_bf16 v[68:71], a[232:235], a[52:55], v[68:71]
v_mul_f32 v86, v29, v86
v_mfma_f32_16x16x32_bf16 v[68:71], a[236:239], a[76:79], v[68:71]
v_mul_f32 v87, v29, v87
v_mfma_f32_16x16x32_bf16 v[68:71], a[240:243], a[100:103], v[68:71]
v_cvt_pk_bf16_f32 v54, v84, v85
v_mfma_f32_16x16x32_bf16 v[68:71], a[244:247], a[124:127], v[68:71]
v_cvt_pk_bf16_f32 v55, v86, v87
v_mfma_f32_16x16x32_bf16 v[68:71], a[248:251], a[148:151], v[68:71]
buffer_store_dwordx4 v[52:55], v23, s[28:31], s46 offen offset:2048 sc1
v_mfma_f32_16x16x32_bf16 v[68:71], a[252:255], a[172:175], v[68:71]
s_waitcnt vmcnt(8)
s_barrier
v_mfma_f32_16x16x32_bf16 v[72:75], a[224:227], a[8:11], 0
ds_read_b64_tr_b16 a[192:193], v38 offset:0
v_mul_f32 v64, v24, v64
v_mfma_f32_16x16x32_bf16 v[72:75], a[228:231], a[32:35], v[72:75]
v_mul_f32 v65, v24, v65
v_mfma_f32_16x16x32_bf16 v[72:75], a[232:235], a[56:59], v[72:75]
ds_read_b64_tr_b16 a[194:195], v38 offset:512
v_mfma_f32_16x16x32_bf16 v[72:75], a[236:239], a[80:83], v[72:75]
v_mul_f32 v66, v24, v66
s_add_u32 m0, s33, 32768
s_nop 0
buffer_load_dwordx4 v160, s[24:27], s42 offen  lds
v_mfma_f32_16x16x32_bf16 v[72:75], a[240:243], a[104:107], v[72:75]
v_mul_f32 v67, v24, v67
ds_read_b64_tr_b16 a[196:197], v38 offset:4096
v_mfma_f32_16x16x32_bf16 v[72:75], a[244:247], a[128:131], v[72:75]
v_cvt_pk_bf16_f32 v52, v64, v65
v_mfma_f32_16x16x32_bf16 v[72:75], a[248:251], a[152:155], v[72:75]
buffer_load_dwordx4 v161, s[24:27], s42 offen offset:1024  lds
v_cvt_pk_bf16_f32 v53, v66, v67
v_mfma_f32_16x16x32_bf16 v[72:75], a[252:255], a[176:179], v[72:75]
ds_read_b64_tr_b16 a[198:199], v38 offset:4608
v_mfma_f32_16x16x32_bf16 v[76:79], a[224:227], a[12:15], 0
v_mul_f32 v68, v25, v68
ds_read_b64_tr_b16 a[200:201], v38 offset:8192
v_mfma_f32_16x16x32_bf16 v[76:79], a[228:231], a[36:39], v[76:79]
v_mul_f32 v69, v25, v69
buffer_load_dwordx4 v162, s[24:27], s42 offen offset:2048  lds
v_mfma_f32_16x16x32_bf16 v[76:79], a[232:235], a[60:63], v[76:79]
v_mul_f32 v70, v25, v70
v_mfma_f32_16x16x32_bf16 v[76:79], a[236:239], a[84:87], v[76:79]
ds_read_b64_tr_b16 a[202:203], v38 offset:8704
v_mul_f32 v71, v25, v71
v_mfma_f32_16x16x32_bf16 v[76:79], a[240:243], a[108:111], v[76:79]
ds_read_b64_tr_b16 a[204:205], v38 offset:12288
v_cvt_pk_bf16_f32 v54, v68, v69
v_mfma_f32_16x16x32_bf16 v[76:79], a[244:247], a[132:135], v[76:79]
buffer_load_dwordx4 v163, s[24:27], s42 offen offset:3072  lds
v_mfma_f32_16x16x32_bf16 v[76:79], a[248:251], a[156:159], v[76:79]
v_cvt_pk_bf16_f32 v55, v70, v71
ds_read_b64_tr_b16 a[206:207], v38 offset:12800
v_mfma_f32_16x16x32_bf16 v[76:79], a[252:255], a[180:183], v[76:79]
buffer_store_dwordx4 v[52:55], v23, s[28:31], s47 offen offset:0 sc1
v_mfma_f32_16x16x32_bf16 v[80:83], a[224:227], a[16:19], 0
v_mul_f32 v72, v26, v72
ds_read_b64_tr_b16 a[208:209], v38 offset:16384
v_mfma_f32_16x16x32_bf16 v[80:83], a[228:231], a[40:43], v[80:83]
v_mul_f32 v73, v26, v73
v_mfma_f32_16x16x32_bf16 v[80:83], a[232:235], a[64:67], v[80:83]
s_add_u32 m0, s33, 36864
s_nop 0
buffer_load_dwordx4 v164, s[24:27], s42 offen  lds
v_mul_f32 v74, v26, v74
v_mfma_f32_16x16x32_bf16 v[80:83], a[236:239], a[88:91], v[80:83]
ds_read_b64_tr_b16 a[210:211], v38 offset:16896
v_mfma_f32_16x16x32_bf16 v[80:83], a[240:243], a[112:115], v[80:83]
v_mul_f32 v75, v26, v75
ds_read_b64_tr_b16 a[212:213], v38 offset:20480
v_mfma_f32_16x16x32_bf16 v[80:83], a[244:247], a[136:139], v[80:83]
v_cvt_pk_bf16_f32 v56, v72, v73
v_mfma_f32_16x16x32_bf16 v[80:83], a[248:251], a[160:163], v[80:83]
buffer_load_dwordx4 v165, s[24:27], s42 offen offset:1024  lds
v_cvt_pk_bf16_f32 v57, v74, v75
v_mfma_f32_16x16x32_bf16 v[80:83], a[252:255], a[184:187], v[80:83]
ds_read_b64_tr_b16 a[214:215], v38 offset:20992
v_mfma_f32_16x16x32_bf16 v[84:87], a[224:227], a[20:23], 0
v_mul_f32 v76, v27, v76
ds_read_b64_tr_b16 a[216:217], v38 offset:24576
v_mfma_f32_16x16x32_bf16 v[84:87], a[228:231], a[44:47], v[84:87]
v_mul_f32 v77, v27, v77
buffer_load_dwordx4 v166, s[24:27], s42 offen offset:2048  lds
v_mfma_f32_16x16x32_bf16 v[84:87], a[232:235], a[68:71], v[84:87]
v_mul_f32 v78, v27, v78
v_mfma_f32_16x16x32_bf16 v[84:87], a[236:239], a[92:95], v[84:87]
ds_read_b64_tr_b16 a[218:219], v38 offset:25088
v_mul_f32 v79, v27, v79
v_mfma_f32_16x16x32_bf16 v[84:87], a[240:243], a[116:119], v[84:87]
ds_read_b64_tr_b16 a[220:221], v38 offset:28672
v_cvt_pk_bf16_f32 v58, v76, v77
v_mfma_f32_16x16x32_bf16 v[84:87], a[244:247], a[140:143], v[84:87]
buffer_load_dwordx4 v167, s[24:27], s42 offen offset:3072  lds
v_mfma_f32_16x16x32_bf16 v[84:87], a[248:251], a[164:167], v[84:87]
v_cvt_pk_bf16_f32 v59, v78, v79
ds_read_b64_tr_b16 a[222:223], v38 offset:29184
v_mfma_f32_16x16x32_bf16 v[84:87], a[252:255], a[188:191], v[84:87]
buffer_store_dwordx4 v[56:59], v23, s[28:31], s47 offen offset:1024 sc1
s_waitcnt lgkmcnt(14)
v_mfma_f32_16x16x32_bf16 v[64:67], a[192:195], a[0:3], 0
v_mul_f32 v80, v28, v80
s_waitcnt lgkmcnt(12)
v_mfma_f32_16x16x32_bf16 v[64:67], a[196:199], a[24:27], v[64:67]
v_mul_f32 v81, v28, v81
s_waitcnt lgkmcnt(10)
v_mfma_f32_16x16x32_bf16 v[64:67], a[200:203], a[48:51], v[64:67]
v_mul_f32 v82, v28, v82
s_waitcnt lgkmcnt(8)
v_mfma_f32_16x16x32_bf16 v[64:67], a[204:207], a[72:75], v[64:67]
s_waitcnt lgkmcnt(6)
v_mfma_f32_16x16x32_bf16 v[64:67], a[208:211], a[96:99], v[64:67]
v_mul_f32 v83, v28, v83
s_waitcnt lgkmcnt(4)
v_mfma_f32_16x16x32_bf16 v[64:67], a[212:215], a[120:123], v[64:67]
v_cvt_pk_bf16_f32 v52, v80, v81
s_waitcnt lgkmcnt(2)
v_mfma_f32_16x16x32_bf16 v[64:67], a[216:219], a[144:147], v[64:67]
v_cvt_pk_bf16_f32 v53, v82, v83
s_waitcnt lgkmcnt(0)
v_mfma_f32_16x16x32_bf16 v[64:67], a[220:223], a[168:171], v[64:67]
v_mfma_f32_16x16x32_bf16 v[68:71], a[192:195], a[4:7], 0
v_mul_f32 v84, v29, v84
v_mfma_f32_16x16x32_bf16 v[68:71], a[196:199], a[28:31], v[68:71]
v_mul_f32 v85, v29, v85
v_mfma_f32_16x16x32_bf16 v[68:71], a[200:203], a[52:55], v[68:71]
v_mul_f32 v86, v29, v86
v_mfma_f32_16x16x32_bf16 v[68:71], a[204:207], a[76:79], v[68:71]
v_mul_f32 v87, v29, v87
v_mfma_f32_16x16x32_bf16 v[68:71], a[208:211], a[100:103], v[68:71]
v_cvt_pk_bf16_f32 v54, v84, v85
v_mfma_f32_16x16x32_bf16 v[68:71], a[212:215], a[124:127], v[68:71]
v_cvt_pk_bf16_f32 v55, v86, v87
v_mfma_f32_16x16x32_bf16 v[68:71], a[216:219], a[148:151], v[68:71]
buffer_store_dwordx4 v[52:55], v23, s[28:31], s47 offen offset:2048 sc1
v_mfma_f32_16x16x32_bf16 v[68:71], a[220:223], a[172:175], v[68:71]
s_waitcnt vmcnt(8)
s_barrier
v_mfma_f32_16x16x32_bf16 v[72:75], a[192:195], a[8:11], 0
v_mul_f32 v64, v24, v64
ds_read_b64_tr_b16 a[224:225], v20 offset:0
v_mfma_f32_16x16x32_bf16 v[72:75], a[196:199], a[32:35], v[72:75]
v_mul_f32 v65, v24, v65
v_mfma_f32_16x16x32_bf16 v[72:75], a[200:203], a[56:59], v[72:75]
ds_read_b64_tr_b16 a[226:227], v20 offset:512
v_mfma_f32_16x16x32_bf16 v[72:75], a[204:207], a[80:83], v[72:75]
v_mul_f32 v66, v24, v66
v_mfma_f32_16x16x32_bf16 v[72:75], a[208:211], a[104:107], v[72:75]
v_mul_f32 v67, v24, v67
ds_read_b64_tr_b16 a[228:229], v20 offset:4096
v_mfma_f32_16x16x32_bf16 v[72:75], a[212:215], a[128:131], v[72:75]
v_cvt_pk_bf16_f32 v52, v64, v65
v_mfma_f32_16x16x32_bf16 v[72:75], a[216:219], a[152:155], v[72:75]
ds_read_b64_tr_b16 a[230:231], v20 offset:4608
v_mfma_f32_16x16x32_bf16 v[72:75], a[220:223], a[176:179], v[72:75]
v_cvt_pk_bf16_f32 v53, v66, v67
v_mfma_f32_16x16x32_bf16 v[76:79], a[192:195], a[12:15], 0
v_mul_f32 v68, v25, v68
ds_read_b64_tr_b16 a[232:233], v20 offset:8192
v_mfma_f32_16x16x32_bf16 v[76:79], a[196:199], a[36:39], v[76:79]
v_mul_f32 v69, v25, v69
v_mfma_f32_16x16x32_bf16 v[76:79], a[200:203], a[60:63], v[76:79]
ds_read_b64_tr_b16 a[234:235], v20 offset:8704
v_mul_f32 v70, v25, v70
v_mfma_f32_16x16x32_bf16 v[76:79], a[204:207], a[84:87], v[76:79]
v_mul_f32 v71, v25, v71
v_mfma_f32_16x16x32_bf16 v[76:79], a[208:211], a[108:111], v[76:79]
ds_read_b64_tr_b16 a[236:237], v20 offset:12288
v_mfma_f32_16x16x32_bf16 v[76:79], a[212:215], a[132:135], v[76:79]
v_cvt_pk_bf16_f32 v54, v68, v69
v_cvt_pk_bf16_f32 v55, v70, v71
v_mfma_f32_16x16x32_bf16 v[76:79], a[216:219], a[156:159], v[76:79]
ds_read_b64_tr_b16 a[238:239], v20 offset:12800
v_mfma_f32_16x16x32_bf16 v[76:79], a[220:223], a[180:183], v[76:79]
buffer_store_dwordx4 v[52:55], v23, s[28:31], s48 offen offset:0 sc1
v_mfma_f32_16x16x32_bf16 v[80:83], a[192:195], a[16:19], 0
v_mul_f32 v72, v26, v72
ds_read_b64_tr_b16 a[240:241], v20 offset:16384
v_mfma_f32_16x16x32_bf16 v[80:83], a[196:199], a[40:43], v[80:83]
v_mul_f32 v73, v26, v73
v_mfma_f32_16x16x32_bf16 v[80:83], a[200:203], a[64:67], v[80:83]
ds_read_b64_tr_b16 a[242:243], v20 offset:16896
v_mfma_f32_16x16x32_bf16 v[80:83], a[204:207], a[88:91], v[80:83]
v_mul_f32 v74, v26, v74
v_mfma_f32_16x16x32_bf16 v[80:83], a[208:211], a[112:115], v[80:83]
v_mul_f32 v75, v26, v75
ds_read_b64_tr_b16 a[244:245], v20 offset:20480
v_mfma_f32_16x16x32_bf16 v[80:83], a[212:215], a[136:139], v[80:83]
v_cvt_pk_bf16_f32 v56, v72, v73
v_mfma_f32_16x16x32_bf16 v[80:83], a[216:219], a[160:163], v[80:83]
ds_read_b64_tr_b16 a[246:247], v20 offset:20992
v_mfma_f32_16x16x32_bf16 v[80:83], a[220:223], a[184:187], v[80:83]
v_cvt_pk_bf16_f32 v57, v74, v75
v_mfma_f32_16x16x32_bf16 v[84:87], a[192:195], a[20:23], 0
v_mul_f32 v76, v27, v76
ds_read_b64_tr_b16 a[248:249], v20 offset:24576
v_mfma_f32_16x16x32_bf16 v[84:87], a[196:199], a[44:47], v[84:87]
v_mul_f32 v77, v27, v77
v_mfma_f32_16x16x32_bf16 v[84:87], a[200:203], a[68:71], v[84:87]
ds_read_b64_tr_b16 a[250:251], v20 offset:25088
v_mul_f32 v78, v27, v78
v_mfma_f32_16x16x32_bf16 v[84:87], a[204:207], a[92:95], v[84:87]
v_mul_f32 v79, v27, v79
v_mfma_f32_16x16x32_bf16 v[84:87], a[208:211], a[116:119], v[84:87]
ds_read_b64_tr_b16 a[252:253], v20 offset:28672
v_mfma_f32_16x16x32_bf16 v[84:87], a[212:215], a[140:143], v[84:87]
v_cvt_pk_bf16_f32 v58, v76, v77
v_cvt_pk_bf16_f32 v59, v78, v79
v_mfma_f32_16x16x32_bf16 v[84:87], a[216:219], a[164:167], v[84:87]
ds_read_b64_tr_b16 a[254:255], v20 offset:29184
v_mfma_f32_16x16x32_bf16 v[84:87], a[220:223], a[188:191], v[84:87]
buffer_store_dwordx4 v[56:59], v23, s[28:31], s48 offen offset:1024 sc1
s_waitcnt lgkmcnt(14)
v_mfma_f32_16x16x32_bf16 v[64:67], a[224:227], a[0:3], 0
v_mul_f32 v80, v28, v80
s_waitcnt lgkmcnt(12)
v_mfma_f32_16x16x32_bf16 v[64:67], a[228:231], a[24:27], v[64:67]
v_mul_f32 v81, v28, v81
s_waitcnt lgkmcnt(10)
v_mfma_f32_16x16x32_bf16 v[64:67], a[232:235], a[48:51], v[64:67]
v_mul_f32 v82, v28, v82
s_waitcnt lgkmcnt(8)
v_mfma_f32_16x16x32_bf16 v[64:67], a[236:239], a[72:75], v[64:67]
s_waitcnt lgkmcnt(6)
v_mfma_f32_16x16x32_bf16 v[64:67], a[240:243], a[96:99], v[64:67]
v_mul_f32 v83, v28, v83
s_waitcnt lgkmcnt(4)
v_mfma_f32_16x16x32_bf16 v[64:67], a[244:247], a[120:123], v[64:67]
v_cvt_pk_bf16_f32 v52, v80, v81
s_waitcnt lgkmcnt(2)
v_mfma_f32_16x16x32_bf16 v[64:67], a[248:251], a[144:147], v[64:67]
v_cvt_pk_bf16_f32 v53, v82, v83
s_waitcnt lgkmcnt(0)
v_mfma_f32_16x16x32_bf16 v[64:67], a[252:255], a[168:171], v[64:67]
v_mfma_f32_16x16x32_bf16 v[68:71], a[224:227], a[4:7], 0
v_mul_f32 v84, v29, v84
v_mfma_f32_16x16x32_bf16 v[68:71], a[228:231], a[28:31], v[68:71]
v_mul_f32 v85, v29, v85
v_mfma_f32_16x16x32_bf16 v[68:71], a[232:235], a[52:55], v[68:71]
v_mul_f32 v86, v29, v86
v_mfma_f32_16x16x32_bf16 v[68:71], a[236:239], a[76:79], v[68:71]
v_mul_f32 v87, v29, v87
v_mfma_f32_16x16x32_bf16 v[68:71], a[240:243], a[100:103], v[68:71]
v_cvt_pk_bf16_f32 v54, v84, v85
v_mfma_f32_16x16x32_bf16 v[68:71], a[244:247], a[124:127], v[68:71]
v_cvt_pk_bf16_f32 v55, v86, v87
v_mfma_f32_16x16x32_bf16 v[68:71], a[248:251], a[148:151], v[68:71]
buffer_store_dwordx4 v[52:55], v23, s[28:31], s48 offen offset:2048 sc1
v_mfma_f32_16x16x32_bf16 v[68:71], a[252:255], a[172:175], v[68:71]
s_waitcnt vmcnt(0)
s_barrier
s_cmp_lg_u32 s3, 0
s_cbranch_scc1 L_nofl0
v_mov_b32 v42, s94
s_lshl_b32 s4, s81, 2
s_add_u32 s4, s4, 0
v_mov_b32 v43, s4
s_mov_b64 exec, 1
global_store_dword v43, v42, s[68:69] sc1
s_mov_b64 exec, -1
s_nop 4
L_nofl0:
v_mfma_f32_16x16x32_bf16 v[72:75], a[224:227], a[8:11], 0
v_mul_f32 v64, v24, v64
ds_read_b64_tr_b16 a[192:193], v20 offset:32768
v_mfma_f32_16x16x32_bf16 v[72:75], a[228:231], a[32:35], v[72:75]
v_mul_f32 v65, v24, v65
v_mfma_f32_16x16x32_bf16 v[72:75], a[232:235], a[56:59], v[72:75]
ds_read_b64_tr_b16 a[194:195], v20 offset:33280
v_mfma_f32_16x16x32_bf16 v[72:75], a[236:239], a[80:83], v[72:75]
v_mul_f32 v66, v24, v66
v_mfma_f32_16x16x32_bf16 v[72:75], a[240:243], a[104:107], v[72:75]
v_mul_f32 v67, v24, v67
ds_read_b64_tr_b16 a[196:197], v20 offset:36864
v_mfma_f32_16x16x32_bf16 v[72:75], a[244:247], a[128:131], v[72:75]
v_cvt_pk_bf16_f32 v52, v64, v65
v_mfma_f32_16x16x32_bf16 v[72:75], a[248:251], a[152:155], v[72:75]
ds_read_b64_tr_b16 a[198:199], v20 offset:37376
v_mfma_f32_16x16x32_bf16 v[72:75], a[252:255], a[176:179], v[72:75]
v_cvt_pk_bf16_f32 v53, v66, v67
v_mfma_f32_16x16x32_bf16 v[76:79], a[224:227], a[12:15], 0
v_mul_f32 v68, v25, v68
ds_read_b64_tr_b16 a[200:201], v20 offset:40960
v_mfma_f32_16x16x32_bf16 v[76:79], a[228:231], a[36:39], v[76:79]
v_mul_f32 v69, v25, v69
v_mfma_f32_16x16x32_bf16 v[76:79], a[232:235], a[60:63], v[76:79]
ds_read_b64_tr_b16 a[202:203], v20 offset:41472
v_mul_f32 v70, v25, v70
v_mfma_f32_16x16x32_bf16 v[76:79], a[236:239], a[84:87], v[76:79]
v_mul_f32 v71, v25, v71
v_mfma_f32_16x16x32_bf16 v[76:79], a[240:243], a[108:111], v[76:79]
ds_read_b64_tr_b16 a[204:205], v20 offset:45056
v_mfma_f32_16x16x32_bf16 v[76:79], a[244:247], a[132:135], v[76:79]
v_cvt_pk_bf16_f32 v54, v68, v69
v_cvt_pk_bf16_f32 v55, v70, v71
v_mfma_f32_16x16x32_bf16 v[76:79], a[248:251], a[156:159], v[76:79]
ds_read_b64_tr_b16 a[206:207], v20 offset:45568
v_mfma_f32_16x16x32_bf16 v[76:79], a[252:255], a[180:183], v[76:79]
buffer_store_dwordx4 v[52:55], v23, s[28:31], s49 offen offset:0 sc1
v_mfma_f32_16x16x32_bf16 v[80:83], a[224:227], a[16:19], 0
v_mul_f32 v72, v26, v72
ds_read_b64_tr_b16 a[208:209], v20 offset:49152
v_mfma_f32_16x16x32_bf16 v[80:83], a[228:231], a[40:43], v[80:83]
v_mul_f32 v73, v26, v73
v_mfma_f32_16x16x32_bf16 v[80:83], a[232:235], a[64:67], v[80:83]
ds_read_b64_tr_b16 a[210:211], v20 offset:49664
v_mfma_f32_16x16x32_bf16 v[80:83], a[236:239], a[88:91], v[80:83]
v_mul_f32 v74, v26, v74
v_mfma_f32_16x16x32_bf16 v[80:83], a[240:243], a[112:115], v[80:83]
v_mul_f32 v75, v26, v75
ds_read_b64_tr_b16 a[212:213], v20 offset:53248
v_mfma_f32_16x16x32_bf16 v[80:83], a[244:247], a[136:139], v[80:83]
v_cvt_pk_bf16_f32 v56, v72, v73
v_mfma_f32_16x16x32_bf16 v[80:83], a[248:251], a[160:163], v[80:83]
ds_read_b64_tr_b16 a[214:215], v20 offset:53760
v_mfma_f32_16x16x32_bf16 v[80:83], a[252:255], a[184:187], v[80:83]
v_cvt_pk_bf16_f32 v57, v74, v75
v_mfma_f32_16x16x32_bf16 v[84:87], a[224:227], a[20:23], 0
v_mul_f32 v76, v27, v76
ds_read_b64_tr_b16 a[216:217], v20 offset:57344
v_mfma_f32_16x16x32_bf16 v[84:87], a[228:231], a[44:47], v[84:87]
v_mul_f32 v77, v27, v77
v_mfma_f32_16x16x32_bf16 v[84:87], a[232:235], a[68:71], v[84:87]
ds_read_b64_tr_b16 a[218:219], v20 offset:57856
v_mul_f32 v78, v27, v78
v_mfma_f32_16x16x32_bf16 v[84:87], a[236:239], a[92:95], v[84:87]
v_mul_f32 v79, v27, v79
v_mfma_f32_16x16x32_bf16 v[84:87], a[240:243], a[116:119], v[84:87]
ds_read_b64_tr_b16 a[220:221], v20 offset:61440
v_mfma_f32_16x16x32_bf16 v[84:87], a[244:247], a[140:143], v[84:87]
v_cvt_pk_bf16_f32 v58, v76, v77
v_cvt_pk_bf16_f32 v59, v78, v79
v_mfma_f32_16x16x32_bf16 v[84:87], a[248:251], a[164:167], v[84:87]
ds_read_b64_tr_b16 a[222:223], v20 offset:61952
v_mfma_f32_16x16x32_bf16 v[84:87], a[252:255], a[188:191], v[84:87]
buffer_store_dwordx4 v[56:59], v23, s[28:31], s49 offen offset:1024 sc1
s_waitcnt lgkmcnt(14)
v_mfma_f32_16x16x32_bf16 v[64:67], a[192:195], a[0:3], 0
v_mul_f32 v80, v28, v80
s_waitcnt lgkmcnt(12)
v_mfma_f32_16x16x32_bf16 v[64:67], a[196:199], a[24:27], v[64:67]
v_mul_f32 v81, v28, v81
s_waitcnt lgkmcnt(10)
v_mfma_f32_16x16x32_bf16 v[64:67], a[200:203], a[48:51], v[64:67]
v_mul_f32 v82, v28, v82
s_waitcnt lgkmcnt(8)
v_mfma_f32_16x16x32_bf16 v[64:67], a[204:207], a[72:75], v[64:67]
s_waitcnt lgkmcnt(6)
v_mfma_f32_16x16x32_bf16 v[64:67], a[208:211], a[96:99], v[64:67]
v_mul_f32 v83, v28, v83
s_waitcnt lgkmcnt(4)
v_mfma_f32_16x16x32_bf16 v[64:67], a[212:215], a[120:123], v[64:67]
v_cvt_pk_bf16_f32 v52, v80, v81
s_waitcnt lgkmcnt(2)
v_mfma_f32_16x16x32_bf16 v[64:67], a[216:219], a[144:147], v[64:67]
v_cvt_pk_bf16_f32 v53, v82, v83
s_waitcnt lgkmcnt(0)
v_mfma_f32_16x16x32_bf16 v[64:67], a[220:223], a[168:171], v[64:67]
v_mfma_f32_16x16x32_bf16 v[68:71], a[192:195], a[4:7], 0
v_mul_f32 v84, v29, v84
v_mfma_f32_16x16x32_bf16 v[68:71], a[196:199], a[28:31], v[68:71]
v_mul_f32 v85, v29, v85
v_mfma_f32_16x16x32_bf16 v[68:71], a[200:203], a[52:55], v[68:71]
v_mul_f32 v86, v29, v86
v_mfma_f32_16x16x32_bf16 v[68:71], a[204:207], a[76:79], v[68:71]
v_mul_f32 v87, v29, v87
v_mfma_f32_16x16x32_bf16 v[68:71], a[208:211], a[100:103], v[68:71]
v_cvt_pk_bf16_f32 v54, v84, v85
v_mfma_f32_16x16x32_bf16 v[68:71], a[212:215], a[124:127], v[68:71]
v_cvt_pk_bf16_f32 v55, v86, v87
v_mfma_f32_16x16x32_bf16 v[68:71], a[216:219], a[148:151], v[68:71]
buffer_store_dwordx4 v[52:55], v23, s[28:31], s49 offen offset:2048 sc1
v_mfma_f32_16x16x32_bf16 v[68:71], a[220:223], a[172:175], v[68:71]
v_mfma_f32_16x16x32_bf16 v[72:75], a[192:195], a[8:11], 0
v_mul_f32 v64, v24, v64
v_mfma_f32_16x16x32_bf16 v[72:75], a[196:199], a[32:35], v[72:75]
s_mov_b32 s78, 0x40000000
v_mfma_f32_16x16x32_bf16 v[72:75], a[200:203], a[56:59], v[72:75]
v_mul_f32 v65, v24, v65
v_mfma_f32_16x16x32_bf16 v[72:75], a[204:207], a[80:83], v[72:75]
v_mul_f32 v66, v24, v66
v_mfma_f32_16x16x32_bf16 v[72:75], a[208:211], a[104:107], v[72:75]
v_mul_f32 v67, v24, v67
v_mfma_f32_16x16x32_bf16 v[72:75], a[212:215], a[128:131], v[72:75]
v_and_b32 v45, 15, v0
v_lshlrev_b32 v45, 2, v45
global_load_dword v46, v45, s[68:69] offset:0 sc1
v_mfma_f32_16x16x32_bf16 v[72:75], a[216:219], a[152:155], v[72:75]
v_cvt_pk_bf16_f32 v52, v64, v65
v_mfma_f32_16x16x32_bf16 v[72:75], a[220:223], a[176:179], v[72:75]
v_cvt_pk_bf16_f32 v53, v66, v67
v_mfma_f32_16x16x32_bf16 v[76:79], a[192:195], a[12:15], 0
v_mul_f32 v68, v25, v68
v_mfma_f32_16x16x32_bf16 v[76:79], a[196:199], a[36:39], v[76:79]
v_mul_f32 v69, v25, v69
v_mfma_f32_16x16x32_bf16 v[76:79], a[200:203], a[60:63], v[76:79]
v_mul_f32 v70, v25, v70
v_mfma_f32_16x16x32_bf16 v[76:79], a[204:207], a[84:87], v[76:79]
v_mul_f32 v71, v25, v71
v_mfma_f32_16x16x32_bf16 v[76:79], a[208:211], a[108:111], v[76:79]
v_cvt_pk_bf16_f32 v54, v68, v69
v_mfma_f32_16x16x32_bf16 v[76:79], a[212:215], a[132:135], v[76:79]
v_cvt_pk_bf16_f32 v55, v70, v71
v_mfma_f32_16x16x32_bf16 v[76:79], a[216:219], a[156:159], v[76:79]
buffer_store_dwordx4 v[52:55], v23, s[28:31], s50 offen offset:0 sc1
v_mfma_f32_16x16x32_bf16 v[76:79], a[220:223], a[180:183], v[76:79]
v_mfma_f32_16x16x32_bf16 v[80:83], a[192:195], a[16:19], 0
v_mul_f32 v72, v26, v72
v_mfma_f32_16x16x32_bf16 v[80:83], a[196:199], a[40:43], v[80:83]
v_mul_f32 v73, v26, v73
v_mfma_f32_16x16x32_bf16 v[80:83], a[200:203], a[64:67], v[80:83]
v_mul_f32 v74, v26, v74
v_mfma_f32_16x16x32_bf16 v[80:83], a[204:207], a[88:91], v[80:83]
v_mfma_f32_16x16x32_bf16 v[80:83], a[208:211], a[112:115], v[80:83]
v_mul_f32 v75, v26, v75
v_mfma_f32_16x16x32_bf16 v[80:83], a[212:215], a[136:139], v[80:83]
v_cvt_pk_bf16_f32 v56, v72, v73
v_mfma_f32_16x16x32_bf16 v[80:83], a[216:219], a[160:163], v[80:83]
v_cvt_pk_bf16_f32 v57, v74, v75
v_mfma_f32_16x16x32_bf16 v[80:83], a[220:223], a[184:187], v[80:83]
v_mfma_f32_16x16x32_bf16 v[84:87], a[192:195], a[20:23], 0
v_mul_f32 v76, v27, v76
v_mfma_f32_16x16x32_bf16 v[84:87], a[196:199], a[44:47], v[84:87]
v_mul_f32 v77, v27, v77
v_mfma_f32_16x16x32_bf16 v[84:87], a[200:203], a[68:71], v[84:87]
v_mul_f32 v78, v27, v78
v_mfma_f32_16x16x32_bf16 v[84:87], a[204:207], a[92:95], v[84:87]
v_mul_f32 v79, v27, v79
v_mfma_f32_16x16x32_bf16 v[84:87], a[208:211], a[116:119], v[84:87]
v_cvt_pk_bf16_f32 v58, v76, v77
v_mfma_f32_16x16x32_bf16 v[84:87], a[212:215], a[140:143], v[84:87]
v_cvt_pk_bf16_f32 v59, v78, v79
v_mfma_f32_16x16x32_bf16 v[84:87], a[216:219], a[164:167], v[84:87]
buffer_store_dwordx4 v[56:59], v23, s[28:31], s50 offen offset:1024 sc1
v_mfma_f32_16x16x32_bf16 v[84:87], a[220:223], a[188:191], v[84:87]
v_mul_f32 v80, v28, v80
v_mul_f32 v81, v28, v81
v_mul_f32 v82, v28, v82
v_mul_f32 v83, v28, v83
v_cvt_pk_bf16_f32 v52, v80, v81
v_cvt_pk_bf16_f32 v53, v82, v83
s_nop 1
v_mul_f32 v84, v29, v84
v_mul_f32 v85, v29, v85
v_mul_f32 v86, v29, v86
v_mul_f32 v87, v29, v87
v_cvt_pk_bf16_f32 v54, v84, v85
v_cvt_pk_bf16_f32 v55, v86, v87
buffer_store_dwordx4 v[52:55], v23, s[28:31], s50 offen offset:2048 sc1
s_mul_i32 s4, s83, 1376256
s_add_u32 s64, s58, s4
s_addc_u32 s65, s59, 0
s_mov_b32 s66, 1376256
s_mov_b32 s67, 0x20000
s_mul_i32 s70, s79, 172032
s_mul_i32 s4, s82, 896
s_add_u32 s70, s70, s4
v_and_b32 v41, 15, v0
v_mul_u32_u24 v41, 1792, v41
v_lshrrev_b32 v42, 4, v0
v_lshlrev_b32 v42, 3, v42
v_add_u32 v41, v41, v42
s_mov_b32 s74, 0x3f80
s_mov_b32 s75, 0x3f800000
s_lshl_b32 s61, s81, 2
s_add_u32 s61, s61, s3
s_cmp_ge_u32 s61, 60
s_cselect_b32 s61, 127, s61
s_lshl_b32 s62, s3, 4
s_add_u32 s62, s62, s81
s_add_u32 s62, s62, 60
s_waitcnt vmcnt(0)
v_cmp_ne_u32 vcc, s94, v46
s_nop 4
s_cbranch_vccz L_ep0
s_mov_b64 exec, 0xffff
v_lshlrev_b32 v45, 2, v0
s_mov_b32 s60, 0x100000
L_poll0:
global_load_dword v46, v45, s[68:69] offset:0 sc1
s_waitcnt vmcnt(0)
v_cmp_ne_u32 vcc, s94, v46
s_nop 4
s_cbranch_vccz L_polldone0
s_sub_u32 s60, s60, 1
s_cbranch_scc1 L_polldone0
s_sleep 2
s_branch L_poll0
L_polldone0:
s_mov_b64 exec, -1
L_ep0:
s_barrier
s_cmp_lg_u32 s3, 0
s_cbranch_scc1 L_nofl1
v_mov_b32 v42, s94
s_lshl_b32 s4, s81, 2
s_add_u32 s4, s4, 128
v_mov_b32 v43, s4
s_mov_b64 exec, 1
global_store_dword v43, v42, s[68:69] sc1
s_mov_b64 exec, -1
s_nop 4
L_nofl1:
s_mul_hi_u32 s5, s61, 357913942
s_mul_i32 s6, s5, 12
s_sub_u32 s6, s61, s6
s_add_u32 s5, s5, s71
s_cmp_ge_u32 s5, 7
s_cselect_b32 s7, 7, 0
s_sub_u32 s5, s5, s7
s_mul_i32 s72, s5, 12
s_add_u32 s72, s72, s6
s_lshl_b32 s72, s72, 10
s_mul_hi_u32 s7, s6, 1431655766
s_mul_i32 s76, s7, 3
s_sub_u32 s76, s6, s76
s_lshl_b32 s5, s5, 7
s_lshl_b32 s7, s7, 5
s_mul_i32 s76, s76, 57344
s_add_u32 s5, s5, s7
s_add_u32 s5, s5, s76
s_add_u32 s73, s5, s70
s_cmp_ge_u32 s61, 84
s_cselect_b32 s72, 0x40000000, s72
s_cselect_b32 s73, 0x40000000, s73
s_add_u32 s5, s72, 0
buffer_load_dwordx4 v[64:67], v23, s[64:67], s5 offen sc1
s_add_u32 s5, s72, 86016
buffer_load_dwordx4 v[68:71], v23, s[64:67], s5 offen sc1
s_add_u32 s5, s72, 172032
buffer_load_dwordx4 v[72:75], v23, s[64:67], s5 offen sc1
s_add_u32 s5, s72, 258048
buffer_load_dwordx4 v[76:79], v23, s[64:67], s5 offen sc1
s_add_u32 s5, s72, 344064
buffer_load_dwordx4 v[80:83], v23, s[64:67], s5 offen sc1
s_add_u32 s5, s72, 430080
buffer_load_dwordx4 v[84:87], v23, s[64:67], s5 offen sc1
s_add_u32 s5, s72, 516096
buffer_load_dwordx4 v[88:91], v23, s[64:67], s5 offen sc1
s_add_u32 s5, s72, 602112
buffer_load_dwordx4 v[92:95], v23, s[64:67], s5 offen sc1
s_add_u32 s5, s72, 688128
buffer_load_dwordx4 v[96:99], v23, s[64:67], s5 offen sc1
s_add_u32 s5, s72, 774144
buffer_load_dwordx4 v[100:103], v23, s[64:67], s5 offen sc1
s_add_u32 s5, s72, 860160
buffer_load_dwordx4 v[104:107], v23, s[64:67], s5 offen sc1
s_add_u32 s5, s72, 946176
buffer_load_dwordx4 v[108:111], v23, s[64:67], s5 offen sc1
s_add_u32 s5, s72, 1032192
buffer_load_dwordx4 v[112:115], v23, s[64:67], s5 offen sc1
s_add_u32 s5, s72, 1118208
buffer_load_dwordx4 v[116:119], v23, s[64:67], s5 offen sc1
s_add_u32 s5, s72, 1204224
buffer_load_dwordx4 v[120:123], v23, s[64:67], s5 offen sc1
s_add_u32 s5, s72, 1290240
buffer_load_dwordx4 v[124:127], v23, s[64:67], s5 offen sc1
v_and_b32 v45, 15, v0
v_lshlrev_b32 v45, 2, v45
global_load_dword v60, v45, s[68:69] offset:128 sc1
v_mov_b32 v48, 0
v_mov_b32 v49, 0
v_mov_b32 v50, 0
v_mov_b32 v51, 0
v_mov_b32 v52, 0
v_mov_b32 v53, 0
v_mov_b32 v54, 0
v_mov_b32 v55, 0
s_waitcnt vmcnt(16)
v_dot2c_f32_bf16 v48, s74, v64
v_dot2c_f32_bf16 v49, s75, v64
v_dot2c_f32_bf16 v50, s74, v65
v_dot2c_f32_bf16 v51, s75, v65
v_dot2c_f32_bf16 v52, s74, v66
v_dot2c_f32_bf16 v53, s75, v66
v_dot2c_f32_bf16 v54, s74, v67
v_dot2c_f32_bf16 v55, s75, v67
s_waitcnt vmcnt(15)
v_dot2c_f32_bf16 v48, s74, v68
v_dot2c_f32_bf16 v49, s75, v68
v_dot2c_f32_bf16 v50, s74, v69
v_dot2c_f32_bf16 v51, s75, v69
v_dot2c_f32_bf16 v52, s74, v70
v_dot2c_f32_bf16 v53, s75, v70
v_dot2c_f32_bf16 v54, s74, v71
v_dot2c_f32_bf16 v55, s75, v71
s_waitcnt vmcnt(14)
v_dot2c_f32_bf16 v48, s74, v72
v_dot2c_f32_bf16 v49, s75, v72
v_dot2c_f32_bf16 v50, s74, v73
v_dot2c_f32_bf16 v51, s75, v73
v_dot2c_f32_bf16 v52, s74, v74
v_dot2c_f32_bf16 v53, s75, v74
v_dot2c_f32_bf16 v54, s74, v75
v_dot2c_f32_bf16 v55, s75, v75
s_waitcnt vmcnt(13)
v_dot2c_f32_bf16 v48, s74, v76
v_dot2c_f32_bf16 v49, s75, v76
v_dot2c_f32_bf16 v50, s74, v77
v_dot2c_f32_bf16 v51, s75, v77
v_dot2c_f32_bf16 v52, s74, v78
v_dot2c_f32_bf16 v53, s75, v78
v_dot2c_f32_bf16 v54, s74, v79
v_dot2c_f32_bf16 v55, s75, v79
s_waitcnt vmcnt(12)
v_dot2c_f32_bf16 v48, s74, v80
v_dot2c_f32_bf16 v49, s75, v80
v_dot2c_f32_bf16 v50, s74, v81
v_dot2c_f32_bf16 v51, s75, v81
v_dot2c_f32_bf16 v52, s74, v82
v_dot2c_f32_bf16 v53, s75, v82
v_dot2c_f32_bf16 v54, s74, v83
v_dot2c_f32_bf16 v55, s75, v83
s_waitcnt vmcnt(11)
v_dot2c_f32_bf16 v48, s74, v84
v_dot2c_f32_bf16 v49, s75, v84
v_dot2c_f32_bf16 v50, s74, v85
v_dot2c_f32_bf16 v51, s75, v85
v_dot2c_f32_bf16 v52, s74, v86
v_dot2c_f32_bf16 v53, s75, v86
v_dot2c_f32_bf16 v54, s74, v87
v_dot2c_f32_bf16 v55, s75, v87
s_waitcnt vmcnt(10)
v_dot2c_f32_bf16 v48, s74, v88
v_dot2c_f32_bf16 v49, s75, v88
v_dot2c_f32_bf16 v50, s74, v89
v_dot2c_f32_bf16 v51, s75, v89
v_dot2c_f32_bf16 v52, s74, v90
v_dot2c_f32_bf16 v53, s75, v90
v_dot2c_f32_bf16 v54, s74, v91
v_dot2c_f32_bf16 v55, s75, v91
s_waitcnt vmcnt(9)
v_dot2c_f32_bf16 v48, s74, v92
v_dot2c_f32_bf16 v49, s75, v92
v_dot2c_f32_bf16 v50, s74, v93
v_dot2c_f32_bf16 v51, s75, v93
v_dot2c_f32_bf16 v52, s74, v94
v_dot2c_f32_bf16 v53, s75, v94
v_dot2c_f32_bf16 v54, s74, v95
v_dot2c_f32_bf16 v55, s75, v95
s_waitcnt vmcnt(8)
v_dot2c_f32_bf16 v48, s74, v96
v_dot2c_f32_bf16 v49, s75, v96
v_dot2c_f32_bf16 v50, s74, v97
v_dot2c_f32_bf16 v51, s75, v97
v_dot2c_f32_bf16 v52, s74, v98
v_dot2c_f32_bf16 v53, s75, v98
v_dot2c_f32_bf16 v54, s74, v99
v_dot2c_f32_bf16 v55, s75, v99
s_waitcnt vmcnt(7)
v_dot2c_f32_bf16 v48, s74, v100
v_dot2c_f32_bf16 v49, s75, v100
v_dot2c_f32_bf16 v50, s74, v101
v_dot2c_f32_bf16 v51, s75, v101
v_dot2c_f32_bf16 v52, s74, v102
v_dot2c_f32_bf16 v53, s75, v102
v_dot2c_f32_bf16 v54, s74, v103
v_dot2c_f32_bf16 v55, s75, v103
s_waitcnt vmcnt(6)
v_dot2c_f32_bf16 v48, s74, v104
v_dot2c_f32_bf16 v49, s75, v104
v_dot2c_f32_bf16 v50, s74, v105
v_dot2c_f32_bf16 v51, s75, v105
v_dot2c_f32_bf16 v52, s74, v106
v_dot2c_f32_bf16 v53, s75, v106
v_dot2c_f32_bf16 v54, s74, v107
v_dot2c_f32_bf16 v55, s75, v107
s_waitcnt vmcnt(5)
v_dot2c_f32_bf16 v48, s74, v108
v_dot2c_f32_bf16 v49, s75, v108
v_dot2c_f32_bf16 v50, s74, v109
v_dot2c_f32_bf16 v51, s75, v109
v_dot2c_f32_bf16 v52, s74, v110
v_dot2c_f32_bf16 v53, s75, v110
v_dot2c_f32_bf16 v54, s74, v111
v_dot2c_f32_bf16 v55, s75, v111
s_waitcnt vmcnt(4)
v_dot2c_f32_bf16 v48, s74, v112
v_dot2c_f32_bf16 v49, s75, v112
v_dot2c_f32_bf16 v50, s74, v113
v_dot2c_f32_bf16 v51, s75, v113
v_dot2c_f32_bf16 v52, s74, v114
v_dot2c_f32_bf16 v53, s75, v114
v_dot2c_f32_bf16 v54, s74, v115
v_dot2c_f32_bf16 v55, s75, v115
s_waitcnt vmcnt(3)
v_dot2c_f32_bf16 v48, s74, v116
v_dot2c_f32_bf16 v49, s75, v116
v_dot2c_f32_bf16 v50, s74, v117
v_dot2c_f32_bf16 v51, s75, v117
v_dot2c_f32_bf16 v52, s74, v118
v_dot2c_f32_bf16 v53, s75, v118
v_dot2c_f32_bf16 v54, s74, v119
v_dot2c_f32_bf16 v55, s75, v119
s_waitcnt vmcnt(2)
v_dot2c_f32_bf16 v48, s74, v120
v_dot2c_f32_bf16 v49, s75, v120
v_dot2c_f32_bf16 v50, s74, v121
v_dot2c_f32_bf16 v51, s75, v121
v_dot2c_f32_bf16 v52, s74, v122
v_dot2c_f32_bf16 v53, s75, v122
v_dot2c_f32_bf16 v54, s74, v123
v_dot2c_f32_bf16 v55, s75, v123
s_waitcnt vmcnt(1)
v_dot2c_f32_bf16 v48, s74, v124
v_dot2c_f32_bf16 v49, s75, v124
v_dot2c_f32_bf16 v50, s74, v125
v_dot2c_f32_bf16 v51, s75, v125
v_dot2c_f32_bf16 v52, s74, v126
v_dot2c_f32_bf16 v53, s75, v126
v_dot2c_f32_bf16 v54, s74, v127
v_dot2c_f32_bf16 v55, s75, v127
v_cvt_pk_bf16_f32 v56, v48, v49
v_cvt_pk_bf16_f32 v57, v50, v51
v_cvt_pk_bf16_f32 v58, v52, v53
v_cvt_pk_bf16_f32 v59, v54, v55
s_waitcnt vmcnt(0)
v_cmp_ne_u32 vcc, s94, v60
s_nop 4
s_cbranch_vccz L_ep1
s_mov_b64 exec, 0xffff
v_lshlrev_b32 v45, 2, v0
s_mov_b32 s60, 0x100000
L_poll1:
global_load_dword v46, v45, s[68:69] offset:128 sc1
s_waitcnt vmcnt(0)
v_cmp_ne_u32 vcc, s94, v46
s_nop 4
s_cbranch_vccz L_polldone1
s_sub_u32 s60, s60, 1
s_cbranch_scc1 L_polldone1
s_sleep 2
s_branch L_poll1
L_polldone1:
s_mov_b64 exec, -1
L_ep1:
buffer_store_dwordx2 v[56:57], v41, s[52:55], s73 offen
s_add_u32 s5, s73, 28672
buffer_store_dwordx2 v[58:59], v41, s[52:55], s5 offen
s_cmp_ge_u32 s3, 2
s_cbranch_scc1 L_fin
s_mul_hi_u32 s5, s62, 357913942
s_mul_i32 s6, s5, 12
s_sub_u32 s6, s62, s6
s_add_u32 s5, s5, s71
s_cmp_ge_u32 s5, 7
s_cselect_b32 s7, 7, 0
s_sub_u32 s5, s5, s7
s_mul_i32 s72, s5, 12
s_add_u32 s72, s72, s6
s_lshl_b32 s72, s72, 10
s_mul_hi_u32 s7, s6, 1431655766
s_mul_i32 s76, s7, 3
s_sub_u32 s76, s6, s76
s_lshl_b32 s5, s5, 7
s_lshl_b32 s7, s7, 5
s_mul_i32 s76, s76, 57344
s_add_u32 s5, s5, s7
s_add_u32 s5, s5, s76
s_add_u32 s73, s5, s70
s_cmp_ge_u32 s62, 84
s_cselect_b32 s72, 0x40000000, s72
s_cselect_b32 s73, 0x40000000, s73
s_add_u32 s5, s72, 0
buffer_load_dwordx4 v[64:67], v23, s[64:67], s5 offen sc1
s_add_u32 s5, s72, 86016
buffer_load_dwordx4 v[68:71], v23, s[64:67], s5 offen sc1
s_add_u32 s5, s72, 172032
buffer_load_dwordx4 v[72:75], v23, s[64:67], s5 offen sc1
s_add_u32 s5, s72, 258048
buffer_load_dwordx4 v[76:79], v23, s[64:67], s5 offen sc1
s_add_u32 s5, s72, 344064
buffer_load_dwordx4 v[80:83], v23, s[64:67], s5 offen sc1
s_add_u32 s5, s72, 430080
buffer_load_dwordx4 v[84:87], v23, s[64:67], s5 offen sc1
s_add_u32 s5, s72, 516096
buffer_load_dwordx4 v[88:91], v23, s[64:67], s5 offen sc1
s_add_u32 s5, s72, 602112
buffer_load_dwordx4 v[92:95], v23, s[64:67], s5 offen sc1
s_add_u32 s5, s72, 688128
buffer_load_dwordx4 v[96:99], v23, s[64:67], s5 offen sc1
s_add_u32 s5, s72, 774144
buffer_load_dwordx4 v[100:103], v23, s[64:67], s5 offen sc1
s_add_u32 s5, s72, 860160
buffer_load_dwordx4 v[104:107], v23, s[64:67], s5 offen sc1
s_add_u32 s5, s72, 946176
buffer_load_dwordx4 v[108:111], v23, s[64:67], s5 offen sc1
s_add_u32 s5, s72, 1032192
buffer_load_dwordx4 v[112:115], v23, s[64:67], s5 offen sc1
s_add_u32 s5, s72, 1118208
buffer_load_dwordx4 v[116:119], v23, s[64:67], s5 offen sc1
s_add_u32 s5, s72, 1204224
buffer_load_dwordx4 v[120:123], v23, s[64:67], s5 offen sc1
s_add_u32 s5, s72, 1290240
buffer_load_dwordx4 v[124:127], v23, s[64:67], s5 offen sc1
v_mov_b32 v48, 0
v_mov_b32 v49, 0
v_mov_b32 v50, 0
v_mov_b32 v51, 0
v_mov_b32 v52, 0
v_mov_b32 v53, 0
v_mov_b32 v54, 0
v_mov_b32 v55, 0
s_waitcnt vmcnt(15)
v_dot2c_f32_bf16 v48, s74, v64
v_dot2c_f32_bf16 v49, s75, v64
v_dot2c_f32_bf16 v50, s74, v65
v_dot2c_f32_bf16 v51, s75, v65
v_dot2c_f32_bf16 v52, s74, v66
v_dot2c_f32_bf16 v53, s75, v66
v_dot2c_f32_bf16 v54, s74, v67
v_dot2c_f32_bf16 v55, s75, v67
s_waitcnt vmcnt(14)
v_dot2c_f32_bf16 v48, s74, v68
v_dot2c_f32_bf16 v49, s75, v68
v_dot2c_f32_bf16 v50, s74, v69
v_dot2c_f32_bf16 v51, s75, v69
v_dot2c_f32_bf16 v52, s74, v70
v_dot2c_f32_bf16 v53, s75, v70
v_dot2c_f32_bf16 v54, s74, v71
v_dot2c_f32_bf16 v55, s75, v71
s_waitcnt vmcnt(13)
v_dot2c_f32_bf16 v48, s74, v72
v_dot2c_f32_bf16 v49, s75, v72
v_dot2c_f32_bf16 v50, s74, v73
v_dot2c_f32_bf16 v51, s75, v73
v_dot2c_f32_bf16 v52, s74, v74
v_dot2c_f32_bf16 v53, s75, v74
v_dot2c_f32_bf16 v54, s74, v75
v_dot2c_f32_bf16 v55, s75, v75
s_waitcnt vmcnt(12)
v_dot2c_f32_bf16 v48, s74, v76
v_dot2c_f32_bf16 v49, s75, v76
v_dot2c_f32_bf16 v50, s74, v77
v_dot2c_f32_bf16 v51, s75, v77
v_dot2c_f32_bf16 v52, s74, v78
v_dot2c_f32_bf16 v53, s75, v78
v_dot2c_f32_bf16 v54, s74, v79
v_dot2c_f32_bf16 v55, s75, v79
s_waitcnt vmcnt(11)
v_dot2c_f32_bf16 v48, s74, v80
v_dot2c_f32_bf16 v49, s75, v80
v_dot2c_f32_bf16 v50, s74, v81
v_dot2c_f32_bf16 v51, s75, v81
v_dot2c_f32_bf16 v52, s74, v82
v_dot2c_f32_bf16 v53, s75, v82
v_dot2c_f32_bf16 v54, s74, v83
v_dot2c_f32_bf16 v55, s75, v83
s_waitcnt vmcnt(10)
v_dot2c_f32_bf16 v48, s74, v84
v_dot2c_f32_bf16 v49, s75, v84
v_dot2c_f32_bf16 v50, s74, v85
v_dot2c_f32_bf16 v51, s75, v85
v_dot2c_f32_bf16 v52, s74, v86
v_dot2c_f32_bf16 v53, s75, v86
v_dot2c_f32_bf16 v54, s74, v87
v_dot2c_f32_bf16 v55, s75, v87
s_waitcnt vmcnt(9)
v_dot2c_f32_bf16 v48, s74, v88
v_dot2c_f32_bf16 v49, s75, v88
v_dot2c_f32_bf16 v50, s74, v89
v_dot2c_f32_bf16 v51, s75, v89
v_dot2c_f32_bf16 v52, s74, v90
v_dot2c_f32_bf16 v53, s75, v90
v_dot2c_f32_bf16 v54, s74, v91
v_dot2c_f32_bf16 v55, s75, v91
s_waitcnt vmcnt(8)
v_dot2c_f32_bf16 v48, s74, v92
v_dot2c_f32_bf16 v49, s75, v92
v_dot2c_f32_bf16 v50, s74, v93
v_dot2c_f32_bf16 v51, s75, v93
v_dot2c_f32_bf16 v52, s74, v94
v_dot2c_f32_bf16 v53, s75, v94
v_dot2c_f32_bf16 v54, s74, v95
v_dot2c_f32_bf16 v55, s75, v95
s_waitcnt vmcnt(7)
v_dot2c_f32_bf16 v48, s74, v96
v_dot2c_f32_bf16 v49, s75, v96
v_dot2c_f32_bf16 v50, s74, v97
v_dot2c_f32_bf16 v51, s75, v97
v_dot2c_f32_bf16 v52, s74, v98
v_dot2c_f32_bf16 v53, s75, v98
v_dot2c_f32_bf16 v54, s74, v99
v_dot2c_f32_bf16 v55, s75, v99
s_waitcnt vmcnt(6)
v_dot2c_f32_bf16 v48, s74, v100
v_dot2c_f32_bf16 v49, s75, v100
v_dot2c_f32_bf16 v50, s74, v101
v_dot2c_f32_bf16 v51, s75, v101
v_dot2c_f32_bf16 v52, s74, v102
v_dot2c_f32_bf16 v53, s75, v102
v_dot2c_f32_bf16 v54, s74, v103
v_dot2c_f32_bf16 v55, s75, v103
s_waitcnt vmcnt(5)
v_dot2c_f32_bf16 v48, s74, v104
v_dot2c_f32_bf16 v49, s75, v104
v_dot2c_f32_bf16 v50, s74, v105
v_dot2c_f32_bf16 v51, s75, v105
v_dot2c_f32_bf16 v52, s74, v106
v_dot2c_f32_bf16 v53, s75, v106
v_dot2c_f32_bf16 v54, s74, v107
v_dot2c_f32_bf16 v55, s75, v107
s_waitcnt vmcnt(4)
v_dot2c_f32_bf16 v48, s74, v108
v_dot2c_f32_bf16 v49, s75, v108
v_dot2c_f32_bf16 v50, s74, v109
v_dot2c_f32_bf16 v51, s75, v109
v_dot2c_f32_bf16 v52, s74, v110
v_dot2c_f32_bf16 v53, s75, v110
v_dot2c_f32_bf16 v54, s74, v111
v_dot2c_f32_bf16 v55, s75, v111
s_waitcnt vmcnt(3)
v_dot2c_f32_bf16 v48, s74, v112
v_dot2c_f32_bf16 v49, s75, v112
v_dot2c_f32_bf16 v50, s74, v113
v_dot2c_f32_bf16 v51, s75, v113
v_dot2c_f32_bf16 v52, s74, v114
v_dot2c_f32_bf16 v53, s75, v114
v_dot2c_f32_bf16 v54, s74, v115
v_dot2c_f32_bf16 v55, s75, v115
s_waitcnt vmcnt(2)
v_dot2c_f32_bf16 v48, s74, v116
v_dot2c_f32_bf16 v49, s75, v116
v_dot2c_f32_bf16 v50, s74, v117
v_dot2c_f32_bf16 v51, s75, v117
v_dot2c_f32_bf16 v52, s74, v118
v_dot2c_f32_bf16 v53, s75, v118
v_dot2c_f32_bf16 v54, s74, v119
v_dot2c_f32_bf16 v55, s75, v119
s_waitcnt vmcnt(1)
v_dot2c_f32_bf16 v48, s74, v120
v_dot2c_f32_bf16 v49, s75, v120
v_dot2c_f32_bf16 v50, s74, v121
v_dot2c_f32_bf16 v51, s75, v121
v_dot2c_f32_bf16 v52, s74, v122
v_dot2c_f32_bf16 v53, s75, v122
v_dot2c_f32_bf16 v54, s74, v123
v_dot2c_f32_bf16 v55, s75, v123
s_waitcnt vmcnt(0)
v_dot2c_f32_bf16 v48, s74, v124
v_dot2c_f32_bf16 v49, s75, v124
v_dot2c_f32_bf16 v50, s74, v125
v_dot2c_f32_bf16 v51, s75, v125
v_dot2c_f32_bf16 v52, s74, v126
v_dot2c_f32_bf16 v53, s75, v126
v_dot2c_f32_bf16 v54, s74, v127
v_dot2c_f32_bf16 v55, s75, v127
v_cvt_pk_bf16_f32 v56, v48, v49
v_cvt_pk_bf16_f32 v57, v50, v51
v_cvt_pk_bf16_f32 v58, v52, v53
v_cvt_pk_bf16_f32 v59, v54, v55
buffer_store_dwordx2 v[56:57], v41, s[52:55], s73 offen
s_add_u32 s5, s73, 28672
buffer_store_dwordx2 v[58:59], v41, s[52:55], s5 offen
L_fin:
L_k1_end:
s_endpgm
.section .rodata,"a"
.p2align 6
.amdhsa_kernel concat_heads__gqa_block_cached__mha_block_cached__near_ridge_kernel
  .amdhsa_next_free_vgpr 512
  .amdhsa_next_free_sgpr 102
  .amdhsa_accum_offset 256
  .amdhsa_group_segment_fixed_size 0
  .amdhsa_kernarg_size 104
  .amdhsa_user_sgpr_count 2
  .amdhsa_user_sgpr_kernarg_segment_ptr 1
  .amdhsa_system_sgpr_workgroup_id_x 1
  .amdhsa_float_denorm_mode_32 3
.end_amdhsa_kernel
```
